```python
import torch

def _softmax(x, axis=-1):
    return torch.softmax(x, dim=axis)
def _gelu(x):
    return torch.nn.functional.gelu(x, approximate="tanh")
def _silu(x):
    return torch.nn.functional.silu(x)
def _sigmoid(x):
    return torch.sigmoid(x)
def _layernorm(x, axis=-1, eps=1e-5):
    m = x.mean(dim=axis, keepdim=True)
    v = x.var(dim=axis, keepdim=True, unbiased=False)
    return (x - m) / torch.sqrt(v + eps)
def _scatter_add(tgt, idx, src, axis=0):
    return tgt.clone().index_add_(axis, idx, src)
def _segment_sum(src, seg, n):
    out = torch.zeros((n,) + src.shape[1:], dtype=src.dtype)
    return out.index_add_(0, seg, src)
def _pad(x, pw):
    flat = tuple(v for pair in reversed(pw) for v in pair)
    return torch.nn.functional.pad(x, flat)

kernel_name = 'standalone__gqa_block_cached__near_ridge'

def setup_inputs():

    _w = (lambda a: (lambda t: t.to(torch.bfloat16) if t.is_floating_point() else t)(torch.as_tensor(a)))
    B, Sq, D = 8, 32, 512
    Hq, Hkv, Sk, Dh = 32, 8, 2048, 128
    assert Hq % Hkv == 0, (Hq, Hkv)
    return {
        "x": _w((lambda *s: torch.randn(*s, dtype=torch.bfloat16) * 0.8)(B, Sq, D)),
        "k_cache": _w((lambda *s: torch.randn(*s, dtype=torch.bfloat16) * 0.8)(B, Hkv, Sk, Dh)),
        "v_cache": _w((lambda *s: torch.randn(*s, dtype=torch.bfloat16) * 0.05)(B, Hkv, Sk, Dh)),
        "wq": _w((lambda *s: torch.randn(*s, dtype=torch.bfloat16) * 0.8)(D, Hq * Dh) * (D ** -0.5)),
        "wo": _w((lambda *s: torch.randn(*s, dtype=torch.bfloat16) * 0.05)(Hq * Dh, D) * ((Hq * Dh) ** -0.5)),
    }

def reference(x, k_cache, v_cache, wq, wo):
    B, Sq, D = x.shape
    Hq, Dh = 32, 128
    Hkv = k_cache.shape[1]
    rep = Hq // Hkv
    q = (lambda x, *d: x.permute(*d))((x @ wq).reshape(B, Sq, Hq, Dh), 0, 2, 1, 3)
    k = (lambda x, n, axis: torch.repeat_interleave(x, n, dim=axis))(k_cache, rep, axis=1)
    v = (lambda x, n, axis: torch.repeat_interleave(x, n, dim=axis))(v_cache, rep, axis=1)
    scores = torch.einsum("bhqd,bhkd->bhqk", q, k) * (Dh ** -0.5)
    p = _softmax(scores, axis=-1)
    o = torch.einsum("bhqk,bhkd->bhqd", p, v)
    return (lambda x, *d: x.permute(*d))(o, 0, 2, 1, 3).reshape(B, Sq, Hq * Dh) @ wo
```

```asm
; @launch grid=(256,1,1) block=(256,1,1) lds=163840
.amdgcn_target "amdgcn-amd-amdhsa--gfx950"
.text
.globl standalone__gqa_block_cached__near_ridge_kernel
.p2align 8
.type standalone__gqa_block_cached__near_ridge_kernel,@function
standalone__gqa_block_cached__near_ridge_kernel:
  s_cmp_ge_u32 s2, 256
  s_cbranch_scc1 K2_end
  s_load_dwordx2 s[72:73], s[0:1], 24
  s_load_dwordx2 s[68:69], s[0:1], 0
  s_load_dwordx2 s[12:13], s[0:1], 8
  s_load_dwordx2 s[16:17], s[0:1], 16
  s_load_dwordx2 s[24:25], s[0:1], 56
  s_load_dwordx2 s[56:57], s[0:1], 32
  s_load_dwordx2 s[60:61], s[0:1], 40
  s_load_dwordx2 s[76:77], s[0:1], 48
  v_lshrrev_b32 v1, 6, v0
  v_and_b32 v0, 63, v0
  v_readfirstlane_b32 s20, v1
  s_and_b32 s21, s2, 7
  s_lshr_b32 s22, s2, 3
  s_and_b32 s23, s22, 3
  s_lshr_b32 s22, s22, 2
  s_lshl_b32 s47, s21, 2
  s_add_u32 s47, s47, s23
  s_mov_b32 s74, 0x400000
  s_mov_b32 s75, 0x20000
  s_mov_b32 s70, 0x40000
  s_mov_b32 s71, 0x20000
  v_lshrrev_b32 v2, 4, v0
  v_and_b32 v4, 15, v0
  v_lshlrev_b32 v3, 2, v2
  v_xor_b32 v3, v3, v4
  v_lshlrev_b32 v3, 4, v3
  v_lshlrev_b32 v5, 13, v2
  v_add_u32 v20, v5, v3
  s_lshl_b32 s37, s20, 3
  s_and_b32 s37, s37, 15
  v_add_u32 v3, s37, v2
  v_xor_b32 v5, v3, v4
  v_lshlrev_b32 v5, 4, v5
  v_lshlrev_b32 v6, 10, v2
  v_add_u32 v21, v5, v6
  v_add_u32 v3, 4, v3
  v_xor_b32 v5, v3, v4
  v_lshlrev_b32 v5, 4, v5
  v_add_u32 v22, v5, v6
  s_add_u32 s43, s22, s23
  s_and_b32 s43, s43, 3
  s_lshl_b32 s33, s22, 15
  s_lshl_b32 s34, s20, 13
  s_add_u32 s33, s33, s34
  s_lshl_b32 s34, s20, 11
  s_lshl_b32 s30, s20, 18
  s_lshl_b32 s31, s47, 8
  s_add_u32 s30, s30, s31
  s_lshl_b32 s32, s20, 13
  s_add_u32 s32, s32, 8192
  s_waitcnt lgkmcnt(0)
  s_add_u32 s38, s43, 0
  s_and_b32 s38, s38, 3
  s_lshl_b32 s39, s38, 20
  s_add_u32 s39, s39, s30
  s_add_u32 m0, s32, 81920
  s_add_u32 s40, s39, 0
  buffer_load_dwordx4 v20, s[72:75], s40 offen lds
  s_add_u32 m0, s32, 82944
  s_add_u32 s40, s39, 32768
  buffer_load_dwordx4 v20, s[72:75], s40 offen lds
  s_add_u32 m0, s32, 83968
  s_add_u32 s40, s39, 65536
  buffer_load_dwordx4 v20, s[72:75], s40 offen lds
  s_add_u32 m0, s32, 84992
  s_add_u32 s40, s39, 98304
  buffer_load_dwordx4 v20, s[72:75], s40 offen lds
  s_add_u32 m0, s32, 86016
  s_add_u32 s40, s39, 131072
  buffer_load_dwordx4 v20, s[72:75], s40 offen lds
  s_add_u32 m0, s32, 87040
  s_add_u32 s40, s39, 163840
  buffer_load_dwordx4 v20, s[72:75], s40 offen lds
  s_add_u32 m0, s32, 88064
  s_add_u32 s40, s39, 196608
  buffer_load_dwordx4 v20, s[72:75], s40 offen lds
  s_add_u32 m0, s32, 89088
  s_add_u32 s40, s39, 229376
  buffer_load_dwordx4 v20, s[72:75], s40 offen lds
  s_lshl_b32 s39, s38, 8
  s_add_u32 s39, s39, s33
  s_add_u32 m0, s34, 81920
  s_add_u32 s40, s39, 4096
  buffer_load_dwordx4 v21, s[68:71], s39 offen lds
  s_add_u32 m0, s34, 82944
  s_nop 0
  buffer_load_dwordx4 v22, s[68:71], s40 offen lds
  s_add_u32 s38, s43, 1
  s_and_b32 s38, s38, 3
  s_lshl_b32 s39, s38, 20
  s_add_u32 s39, s39, s30
  s_add_u32 m0, s32, 122880
  s_add_u32 s40, s39, 0
  buffer_load_dwordx4 v20, s[72:75], s40 offen lds
  s_add_u32 m0, s32, 123904
  s_add_u32 s40, s39, 32768
  buffer_load_dwordx4 v20, s[72:75], s40 offen lds
  s_add_u32 m0, s32, 124928
  s_add_u32 s40, s39, 65536
  buffer_load_dwordx4 v20, s[72:75], s40 offen lds
  s_add_u32 m0, s32, 125952
  s_add_u32 s40, s39, 98304
  buffer_load_dwordx4 v20, s[72:75], s40 offen lds
  s_add_u32 m0, s32, 126976
  s_add_u32 s40, s39, 131072
  buffer_load_dwordx4 v20, s[72:75], s40 offen lds
  s_add_u32 m0, s32, 128000
  s_add_u32 s40, s39, 163840
  buffer_load_dwordx4 v20, s[72:75], s40 offen lds
  s_add_u32 m0, s32, 129024
  s_add_u32 s40, s39, 196608
  buffer_load_dwordx4 v20, s[72:75], s40 offen lds
  s_add_u32 m0, s32, 130048
  s_add_u32 s40, s39, 229376
  buffer_load_dwordx4 v20, s[72:75], s40 offen lds
  s_lshl_b32 s39, s38, 8
  s_add_u32 s39, s39, s33
  s_add_u32 m0, s34, 122880
  s_add_u32 s40, s39, 4096
  buffer_load_dwordx4 v21, s[68:71], s39 offen lds
  s_add_u32 m0, s34, 123904
  s_nop 0
  buffer_load_dwordx4 v22, s[68:71], s40 offen lds
  s_add_u32 s38, s43, 2
  s_and_b32 s38, s38, 3
  s_lshl_b32 s39, s38, 20
  s_add_u32 s39, s39, s30
  s_add_u32 m0, s32, 40960
  s_add_u32 s40, s39, 0
  buffer_load_dwordx4 v20, s[72:75], s40 offen lds
  s_add_u32 m0, s32, 41984
  s_add_u32 s40, s39, 32768
  buffer_load_dwordx4 v20, s[72:75], s40 offen lds
  s_add_u32 m0, s32, 43008
  s_add_u32 s40, s39, 65536
  buffer_load_dwordx4 v20, s[72:75], s40 offen lds
  s_add_u32 m0, s32, 44032
  s_add_u32 s40, s39, 98304
  buffer_load_dwordx4 v20, s[72:75], s40 offen lds
  s_add_u32 m0, s32, 45056
  s_add_u32 s40, s39, 131072
  buffer_load_dwordx4 v20, s[72:75], s40 offen lds
  s_add_u32 m0, s32, 46080
  s_add_u32 s40, s39, 163840
  buffer_load_dwordx4 v20, s[72:75], s40 offen lds
  s_add_u32 m0, s32, 47104
  s_add_u32 s40, s39, 196608
  buffer_load_dwordx4 v20, s[72:75], s40 offen lds
  s_add_u32 m0, s32, 48128
  s_add_u32 s40, s39, 229376
  buffer_load_dwordx4 v20, s[72:75], s40 offen lds
  s_lshl_b32 s39, s38, 8
  s_add_u32 s39, s39, s33
  s_add_u32 m0, s34, 40960
  s_add_u32 s40, s39, 4096
  buffer_load_dwordx4 v21, s[68:71], s39 offen lds
  s_add_u32 m0, s34, 41984
  s_nop 0
  buffer_load_dwordx4 v22, s[68:71], s40 offen lds
  s_add_u32 s38, s43, 3
  s_and_b32 s38, s38, 3
  s_lshl_b32 s39, s38, 20
  s_add_u32 s39, s39, s30
  s_add_u32 m0, s32, 0
  s_add_u32 s40, s39, 0
  buffer_load_dwordx4 v20, s[72:75], s40 offen lds
  s_add_u32 m0, s32, 1024
  s_add_u32 s40, s39, 32768
  buffer_load_dwordx4 v20, s[72:75], s40 offen lds
  s_add_u32 m0, s32, 2048
  s_add_u32 s40, s39, 65536
  buffer_load_dwordx4 v20, s[72:75], s40 offen lds
  s_add_u32 m0, s32, 3072
  s_add_u32 s40, s39, 98304
  buffer_load_dwordx4 v20, s[72:75], s40 offen lds
  s_add_u32 m0, s32, 4096
  s_add_u32 s40, s39, 131072
  buffer_load_dwordx4 v20, s[72:75], s40 offen lds
  s_add_u32 m0, s32, 5120
  s_add_u32 s40, s39, 163840
  buffer_load_dwordx4 v20, s[72:75], s40 offen lds
  s_add_u32 m0, s32, 6144
  s_add_u32 s40, s39, 196608
  buffer_load_dwordx4 v20, s[72:75], s40 offen lds
  s_add_u32 m0, s32, 7168
  s_add_u32 s40, s39, 229376
  buffer_load_dwordx4 v20, s[72:75], s40 offen lds
  s_lshl_b32 s39, s38, 8
  s_add_u32 s39, s39, s33
  s_add_u32 m0, s34, 0
  s_add_u32 s40, s39, 4096
  buffer_load_dwordx4 v21, s[68:71], s39 offen lds
  s_add_u32 m0, s34, 1024
  s_nop 0
  buffer_load_dwordx4 v22, s[68:71], s40 offen lds
  s_mov_b32 s14, 0x2000000
  s_mov_b32 s15, 0x20000
  s_mov_b32 s18, 0x2000000
  s_mov_b32 s19, 0x20000
  s_mov_b32 s26, 0x10000000
  s_mov_b32 s27, 0x20000
  s_mov_b32 s58, 0x400000
  s_mov_b32 s59, 0x20000
  s_mov_b32 s62, 0x40000
  s_mov_b32 s63, 0x20000
  s_mov_b32 s78, 0x100
  s_mov_b32 s79, 0x20000
  s_lshl_b32 s28, s22, 3
  s_add_u32 s28, s28, s21
  s_lshl_b32 s29, s28, 19
  s_lshl_b32 s30, s23, 17
  s_add_u32 s29, s29, s30
  s_mul_i32 s54, s28, 0x2c000
  s_add_u32 s54, s54, 0x400000
  s_mul_i32 s55, s22, 0x110000
  s_add_u32 s55, s55, 0x1400000
  s_cmp_lg_u32 s20, 0
  s_cbranch_scc1 K2_noat
  s_memrealtime s[82:83]
  v_mov_b32 v30, 0
  v_mov_b32 v31, 0
  v_mov_b32 v7, 0
  s_lshl_b32 s38, s22, 5
  s_waitcnt lgkmcnt(0)
  s_or_b32 s82, s82, 1
  v_mov_b32 v28, s82
  v_mov_b32 v29, s83
  s_mov_b64 exec, 1
  buffer_atomic_cmpswap_x2 v[28:31], v7, s[76:79], s38 offen sc0 sc1
  s_mov_b64 exec, -1
K2_noat:
  v_lshrrev_b32 v2, 4, v0
  v_and_b32 v3, 15, v0
  s_lshl_b32 s31, s20, 3
  s_and_b32 s31, s31, 15
  v_add_u32 v4, s31, v2
  v_xor_b32 v5, v4, v3
  v_lshlrev_b32 v5, 4, v5
  v_lshlrev_b32 v6, 8, v2
  v_add_u32 v8, v5, v6
  v_add_u32 v4, 4, v4
  v_xor_b32 v5, v4, v3
  v_lshlrev_b32 v5, 4, v5
  v_add_u32 v9, v5, v6
  v_lshlrev_b32 v5, 2, v2
  v_xor_b32 v5, v5, v3
  v_lshlrev_b32 v5, 4, v5
  v_add_u32 v10, v5, v6
  v_lshlrev_b32 v11, 4, v0
  s_lshl_b32 s36, s20, 11
  s_add_u32 s66, s29, s36
  s_lshr_b32 s64, s2, 3
  s_and_b32 s64, s64, 15
  s_mov_b32 s65, s64
  s_lshl_b32 s48, s47, 7
  s_add_u32 s48, s48, s20
  s_lshl_b32 s48, s48, 10
  s_mul_i32 s49, s20, 1088
  v_and_b32 v4, 15, v0
  v_lshrrev_b32 v4, 2, v4
  v_lshrrev_b32 v5, 5, v0
  v_lshlrev_b32 v6, 3, v5
  v_add_u32 v6, v6, v4
  v_lshlrev_b32 v6, 8, v6
  v_xor_b32 v7, s20, v4
  v_lshlrev_b32 v7, 6, v7
  v_add_u32 v6, v6, v7
  v_lshrrev_b32 v7, 4, v0
  v_and_b32 v7, 1, v7
  v_lshlrev_b32 v7, 5, v7
  v_add_u32 v6, v6, v7
  v_and_b32 v7, 3, v0
  v_lshlrev_b32 v7, 3, v7
  v_add_u32 v6, v6, v7
  v_add_u32 v6, 90112, v6
  v_and_b32 v1, 31, v0
  v_and_b32 v7, 15, v1
  v_xor_b32 v7, v7, v5
  v_lshlrev_b32 v7, 4, v7
  v_lshlrev_b32 v1, 8, v1
  v_add_u32 v1, 81920, v1
  v_xor_b32 v12, 0, v7
  v_add_u32 v12, v12, v1
  v_xor_b32 v13, 32, v7
  v_add_u32 v13, v13, v1
  v_xor_b32 v14, 64, v7
  v_add_u32 v14, v14, v1
  v_xor_b32 v15, 96, v7
  v_add_u32 v15, v15, v1
  v_xor_b32 v16, 128, v7
  v_add_u32 v16, v16, v1
  v_xor_b32 v17, 160, v7
  v_add_u32 v17, v17, v1
  v_xor_b32 v18, 192, v7
  v_add_u32 v18, v18, v1
  v_xor_b32 v19, 224, v7
  v_add_u32 v19, v19, v1
  s_waitcnt vmcnt(30)
  s_barrier
  ds_read_b64_tr_b16 v[104:105], v6 offset:0
  ds_read_b64_tr_b16 v[106:107], v6 offset:1024
  ds_read_b128 v[136:139], v12
  ds_read_b64_tr_b16 v[108:109], v6 offset:4096
  ds_read_b64_tr_b16 v[110:111], v6 offset:5120
  ds_read_b128 v[140:143], v13
  ds_read_b64_tr_b16 v[112:113], v6 offset:8192
  ds_read_b64_tr_b16 v[114:115], v6 offset:9216
  ds_read_b128 v[144:147], v14
  ds_read_b64_tr_b16 v[116:117], v6 offset:12288
  ds_read_b64_tr_b16 v[118:119], v6 offset:13312
  ds_read_b128 v[148:151], v15
  ds_read_b64_tr_b16 v[120:121], v6 offset:16384
  ds_read_b64_tr_b16 v[122:123], v6 offset:17408
  ds_read_b128 v[152:155], v16
  ds_read_b64_tr_b16 v[124:125], v6 offset:20480
  ds_read_b64_tr_b16 v[126:127], v6 offset:21504
  ds_read_b128 v[156:159], v17
  ds_read_b64_tr_b16 v[128:129], v6 offset:24576
  ds_read_b64_tr_b16 v[130:131], v6 offset:25600
  ds_read_b128 v[160:163], v18
  ds_read_b64_tr_b16 v[132:133], v6 offset:28672
  ds_read_b64_tr_b16 v[134:135], v6 offset:29696
  ds_read_b128 v[164:167], v19
  v_add_u32 v6, 0xa000, v6
  v_add_u32 v12, 0xa000, v12
  v_add_u32 v13, 0xa000, v13
  v_add_u32 v14, 0xa000, v14
  v_add_u32 v15, 0xa000, v15
  v_add_u32 v16, 0xa000, v16
  v_add_u32 v17, 0xa000, v17
  v_add_u32 v18, 0xa000, v18
  v_add_u32 v19, 0xa000, v19
  s_waitcnt lgkmcnt(15)
  v_mfma_f32_32x32x16_bf16 v[48:63], v[104:107], v[136:139], 0
  s_waitcnt lgkmcnt(15)
  v_mfma_f32_32x32x16_bf16 v[48:63], v[108:111], v[140:143], v[48:63]
  s_waitcnt lgkmcnt(15)
  v_mfma_f32_32x32x16_bf16 v[48:63], v[112:115], v[144:147], v[48:63]
  s_waitcnt lgkmcnt(12)
  v_mfma_f32_32x32x16_bf16 v[48:63], v[116:119], v[148:151], v[48:63]
  s_waitcnt lgkmcnt(9)
  v_mfma_f32_32x32x16_bf16 v[48:63], v[120:123], v[152:155], v[48:63]
  s_waitcnt lgkmcnt(6)
  v_mfma_f32_32x32x16_bf16 v[48:63], v[124:127], v[156:159], v[48:63]
  s_waitcnt lgkmcnt(3)
  v_mfma_f32_32x32x16_bf16 v[48:63], v[128:131], v[160:163], v[48:63]
  s_waitcnt lgkmcnt(0)
  v_mfma_f32_32x32x16_bf16 v[48:63], v[132:135], v[164:167], v[48:63]
  s_waitcnt vmcnt(20)
  s_barrier
  s_lshl_b32 s34, s64, 13
  s_add_u32 m0, s36, 81920
  s_add_u32 s34, s34, s66
  buffer_load_dwordx4 v8, s[12:15], s34 offen nt lds
  buffer_load_dwordx4 v9, s[12:15], s34 offen offset:1024 nt lds
  s_add_u32 s64, s64, 1
  s_and_b32 s64, s64, 15
  s_lshl_b32 s34, s64, 13
  s_add_u32 m0, s36, 90112
  s_add_u32 s34, s34, s66
  buffer_load_dwordx4 v8, s[12:15], s34 offen nt lds
  buffer_load_dwordx4 v9, s[12:15], s34 offen offset:1024 nt lds
  s_add_u32 s64, s64, 1
  s_and_b32 s64, s64, 15
  s_lshl_b32 s35, s65, 13
  s_add_u32 m0, s36, 114688
  s_add_u32 s35, s35, s66
  buffer_load_dwordx4 v10, s[16:19], s35 offen nt lds
  buffer_load_dwordx4 v10, s[16:19], s35 offen offset:1024 nt lds
  s_add_u32 s65, s65, 1
  s_and_b32 s65, s65, 15
  ds_read_b64_tr_b16 v[168:169], v6 offset:0
  ds_read_b64_tr_b16 v[170:171], v6 offset:1024
  ds_read_b128 v[200:203], v12
  ds_read_b64_tr_b16 v[172:173], v6 offset:4096
  ds_read_b64_tr_b16 v[174:175], v6 offset:5120
  ds_read_b128 v[204:207], v13
  ds_read_b64_tr_b16 v[176:177], v6 offset:8192
  ds_read_b64_tr_b16 v[178:179], v6 offset:9216
  ds_read_b128 v[208:211], v14
  ds_read_b64_tr_b16 v[180:181], v6 offset:12288
  ds_read_b64_tr_b16 v[182:183], v6 offset:13312
  ds_read_b128 v[212:215], v15
  ds_read_b64_tr_b16 v[184:185], v6 offset:16384
  ds_read_b64_tr_b16 v[186:187], v6 offset:17408
  ds_read_b128 v[216:219], v16
  ds_read_b64_tr_b16 v[188:189], v6 offset:20480
  ds_read_b64_tr_b16 v[190:191], v6 offset:21504
  ds_read_b128 v[220:223], v17
  ds_read_b64_tr_b16 v[192:193], v6 offset:24576
  ds_read_b64_tr_b16 v[194:195], v6 offset:25600
  ds_read_b128 v[224:227], v18
  ds_read_b64_tr_b16 v[196:197], v6 offset:28672
  ds_read_b64_tr_b16 v[198:199], v6 offset:29696
  ds_read_b128 v[228:231], v19
  v_add_u32 v6, 0xfffec000, v6
  v_add_u32 v12, 0xfffec000, v12
  v_add_u32 v13, 0xfffec000, v13
  v_add_u32 v14, 0xfffec000, v14
  v_add_u32 v15, 0xfffec000, v15
  v_add_u32 v16, 0xfffec000, v16
  v_add_u32 v17, 0xfffec000, v17
  v_add_u32 v18, 0xfffec000, v18
  v_add_u32 v19, 0xfffec000, v19
  s_waitcnt lgkmcnt(15)
  v_mfma_f32_32x32x16_bf16 v[48:63], v[168:171], v[200:203], v[48:63]
  s_waitcnt lgkmcnt(15)
  v_mfma_f32_32x32x16_bf16 v[48:63], v[172:175], v[204:207], v[48:63]
  s_waitcnt lgkmcnt(15)
  v_mfma_f32_32x32x16_bf16 v[48:63], v[176:179], v[208:211], v[48:63]
  s_waitcnt lgkmcnt(12)
  v_mfma_f32_32x32x16_bf16 v[48:63], v[180:183], v[212:215], v[48:63]
  s_waitcnt lgkmcnt(9)
  v_mfma_f32_32x32x16_bf16 v[48:63], v[184:187], v[216:219], v[48:63]
  s_waitcnt lgkmcnt(6)
  v_mfma_f32_32x32x16_bf16 v[48:63], v[188:191], v[220:223], v[48:63]
  s_waitcnt lgkmcnt(3)
  v_mfma_f32_32x32x16_bf16 v[48:63], v[192:195], v[224:227], v[48:63]
  s_waitcnt lgkmcnt(0)
  v_mfma_f32_32x32x16_bf16 v[48:63], v[196:199], v[228:231], v[48:63]
  s_waitcnt vmcnt(16)
  s_barrier
  ds_read_b64_tr_b16 v[104:105], v6 offset:0
  ds_read_b64_tr_b16 v[106:107], v6 offset:1024
  ds_read_b128 v[136:139], v12
  ds_read_b64_tr_b16 v[108:109], v6 offset:4096
  ds_read_b64_tr_b16 v[110:111], v6 offset:5120
  ds_read_b128 v[140:143], v13
  ds_read_b64_tr_b16 v[112:113], v6 offset:8192
  ds_read_b64_tr_b16 v[114:115], v6 offset:9216
  ds_read_b128 v[144:147], v14
  ds_read_b64_tr_b16 v[116:117], v6 offset:12288
  ds_read_b64_tr_b16 v[118:119], v6 offset:13312
  ds_read_b128 v[148:151], v15
  ds_read_b64_tr_b16 v[120:121], v6 offset:16384
  ds_read_b64_tr_b16 v[122:123], v6 offset:17408
  ds_read_b128 v[152:155], v16
  ds_read_b64_tr_b16 v[124:125], v6 offset:20480
  ds_read_b64_tr_b16 v[126:127], v6 offset:21504
  ds_read_b128 v[156:159], v17
  ds_read_b64_tr_b16 v[128:129], v6 offset:24576
  ds_read_b64_tr_b16 v[130:131], v6 offset:25600
  ds_read_b128 v[160:163], v18
  ds_read_b64_tr_b16 v[132:133], v6 offset:28672
  ds_read_b64_tr_b16 v[134:135], v6 offset:29696
  ds_read_b128 v[164:167], v19
  v_add_u32 v6, 0xffff6000, v6
  v_add_u32 v12, 0xffff6000, v12
  v_add_u32 v13, 0xffff6000, v13
  v_add_u32 v14, 0xffff6000, v14
  v_add_u32 v15, 0xffff6000, v15
  v_add_u32 v16, 0xffff6000, v16
  v_add_u32 v17, 0xffff6000, v17
  v_add_u32 v18, 0xffff6000, v18
  v_add_u32 v19, 0xffff6000, v19
  s_waitcnt lgkmcnt(15)
  v_mfma_f32_32x32x16_bf16 v[48:63], v[104:107], v[136:139], v[48:63]
  s_waitcnt lgkmcnt(15)
  v_mfma_f32_32x32x16_bf16 v[48:63], v[108:111], v[140:143], v[48:63]
  s_waitcnt lgkmcnt(15)
  v_mfma_f32_32x32x16_bf16 v[48:63], v[112:115], v[144:147], v[48:63]
  s_waitcnt lgkmcnt(12)
  v_mfma_f32_32x32x16_bf16 v[48:63], v[116:119], v[148:151], v[48:63]
  s_waitcnt lgkmcnt(9)
  v_mfma_f32_32x32x16_bf16 v[48:63], v[120:123], v[152:155], v[48:63]
  s_waitcnt lgkmcnt(6)
  v_mfma_f32_32x32x16_bf16 v[48:63], v[124:127], v[156:159], v[48:63]
  s_waitcnt lgkmcnt(3)
  v_mfma_f32_32x32x16_bf16 v[48:63], v[128:131], v[160:163], v[48:63]
  s_waitcnt lgkmcnt(0)
  v_mfma_f32_32x32x16_bf16 v[48:63], v[132:135], v[164:167], v[48:63]
  s_waitcnt vmcnt(6)
  s_cmp_lg_u32 s20, 0
  s_cbranch_scc1 K2_nonl
  v_mov_b32 v1, s82
  v_mov_b32 v2, s83
  v_cmp_eq_u32 vcc, 0, v28
  s_nop 1
  v_cndmask_b32 v28, v28, v1, vcc
  v_cndmask_b32 v29, v29, v2, vcc
  v_mov_b32 v1, 114680
  s_mov_b64 exec, 1
  ds_write_b64 v1, v[28:29]
  s_mov_b64 exec, -1
  s_waitcnt lgkmcnt(0)
K2_nonl:
  s_barrier
  ds_read_b64_tr_b16 v[168:169], v6 offset:0
  ds_read_b64_tr_b16 v[170:171], v6 offset:1024
  ds_read_b128 v[200:203], v12
  ds_read_b64_tr_b16 v[172:173], v6 offset:4096
  ds_read_b64_tr_b16 v[174:175], v6 offset:5120
  ds_read_b128 v[204:207], v13
  ds_read_b64_tr_b16 v[176:177], v6 offset:8192
  ds_read_b64_tr_b16 v[178:179], v6 offset:9216
  ds_read_b128 v[208:211], v14
  ds_read_b64_tr_b16 v[180:181], v6 offset:12288
  ds_read_b64_tr_b16 v[182:183], v6 offset:13312
  ds_read_b128 v[212:215], v15
  ds_read_b64_tr_b16 v[184:185], v6 offset:16384
  ds_read_b64_tr_b16 v[186:187], v6 offset:17408
  ds_read_b128 v[216:219], v16
  ds_read_b64_tr_b16 v[188:189], v6 offset:20480
  ds_read_b64_tr_b16 v[190:191], v6 offset:21504
  ds_read_b128 v[220:223], v17
  ds_read_b64_tr_b16 v[192:193], v6 offset:24576
  ds_read_b64_tr_b16 v[194:195], v6 offset:25600
  ds_read_b128 v[224:227], v18
  ds_read_b64_tr_b16 v[196:197], v6 offset:28672
  ds_read_b64_tr_b16 v[198:199], v6 offset:29696
  ds_read_b128 v[228:231], v19
  v_mov_b32 v1, 114680
  ds_read_b64 v[2:3], v1
  s_waitcnt lgkmcnt(15)
  v_mfma_f32_32x32x16_bf16 v[48:63], v[168:171], v[200:203], v[48:63]
  s_waitcnt lgkmcnt(15)
  v_mfma_f32_32x32x16_bf16 v[48:63], v[172:175], v[204:207], v[48:63]
  s_waitcnt lgkmcnt(15)
  v_mfma_f32_32x32x16_bf16 v[48:63], v[176:179], v[208:211], v[48:63]
  s_waitcnt lgkmcnt(13)
  v_mfma_f32_32x32x16_bf16 v[48:63], v[180:183], v[212:215], v[48:63]
  s_waitcnt lgkmcnt(10)
  v_mfma_f32_32x32x16_bf16 v[48:63], v[184:187], v[216:219], v[48:63]
  s_waitcnt lgkmcnt(7)
  v_mfma_f32_32x32x16_bf16 v[48:63], v[188:191], v[220:223], v[48:63]
  s_waitcnt lgkmcnt(4)
  v_mfma_f32_32x32x16_bf16 v[48:63], v[192:195], v[224:227], v[48:63]
  s_waitcnt lgkmcnt(1)
  v_mfma_f32_32x32x16_bf16 v[48:63], v[196:199], v[228:231], v[48:63]
  s_waitcnt lgkmcnt(0)
  v_readfirstlane_b32 s80, v2
  v_readfirstlane_b32 s81, v3
  s_mov_b32 s50, 0x3e0293ee
  s_lshl_b32 s34, s23, 13
  s_add_u32 s34, s34, s54
  s_add_u32 s34, s34, 0x23000
  s_add_u32 s34, s34, s36
  s_nop 3
  v_mul_f32 v48, s50, v48
  v_mul_f32 v49, s50, v49
  v_mul_f32 v50, s50, v50
  v_mul_f32 v51, s50, v51
  v_mul_f32 v52, s50, v52
  v_mul_f32 v53, s50, v53
  v_mul_f32 v54, s50, v54
  v_mul_f32 v55, s50, v55
  v_mul_f32 v56, s50, v56
  v_mul_f32 v57, s50, v57
  v_mul_f32 v58, s50, v58
  v_mul_f32 v59, s50, v59
  v_mul_f32 v60, s50, v60
  v_mul_f32 v61, s50, v61
  v_mul_f32 v62, s50, v62
  v_mul_f32 v63, s50, v63
  v_cvt_pk_bf16_f32 v80, v48, v49
  v_cvt_pk_bf16_f32 v81, v50, v51
  v_cvt_pk_bf16_f32 v82, v52, v53
  v_cvt_pk_bf16_f32 v83, v54, v55
  v_cvt_pk_bf16_f32 v84, v56, v57
  v_cvt_pk_bf16_f32 v85, v58, v59
  v_cvt_pk_bf16_f32 v86, v60, v61
  v_cvt_pk_bf16_f32 v87, v62, v63
  v_permlane32_swap_b32 v80, v82
  v_permlane32_swap_b32 v81, v83
  v_permlane32_swap_b32 v84, v86
  v_permlane32_swap_b32 v85, v87
  buffer_store_dwordx4 v[80:83], v11, s[24:27], s34 offen sc1
  buffer_store_dwordx4 v[84:87], v11, s[24:27], s34 offen offset:1024 sc1
  v_and_b32 v1, 31, v0
  v_lshrrev_b32 v2, 5, v0
  v_xor_b32 v3, v1, v2
  v_and_b32 v3, 15, v3
  v_lshlrev_b32 v3, 4, v3
  v_lshlrev_b32 v6, 8, v1
  v_add_u32 v6, 0x14000, v6
  v_xor_b32 v12, 0, v3
  v_add_u32 v12, v12, v6
  v_xor_b32 v13, 32, v3
  v_add_u32 v13, v13, v6
  v_xor_b32 v14, 64, v3
  v_add_u32 v14, v14, v6
  v_xor_b32 v15, 96, v3
  v_add_u32 v15, v15, v6
  v_xor_b32 v16, 128, v3
  v_add_u32 v16, v16, v6
  v_xor_b32 v17, 160, v3
  v_add_u32 v17, v17, v6
  v_xor_b32 v18, 192, v3
  v_add_u32 v18, v18, v6
  v_xor_b32 v19, 224, v3
  v_add_u32 v19, v19, v6
  v_and_b32 v3, 15, v0
  v_lshrrev_b32 v3, 2, v3
  v_lshlrev_b32 v6, 2, v2
  v_add_u32 v6, v6, v3
  v_lshlrev_b32 v6, 8, v6
  v_lshrrev_b32 v4, 4, v0
  v_and_b32 v4, 1, v4
  v_lshlrev_b32 v4, 5, v4
  v_add_u32 v6, v6, v4
  v_and_b32 v4, 3, v0
  v_lshlrev_b32 v4, 3, v4
  v_add_u32 v6, v6, v4
  v_add_u32 v6, 0x1c000, v6
  v_xor_b32 v4, 0, v3
  v_lshlrev_b32 v4, 6, v4
  v_add_u32 v20, v6, v4
  v_xor_b32 v4, 1, v3
  v_lshlrev_b32 v4, 6, v4
  v_add_u32 v21, v6, v4
  v_xor_b32 v4, 2, v3
  v_lshlrev_b32 v4, 6, v4
  v_add_u32 v22, v6, v4
  v_xor_b32 v4, 3, v3
  v_lshlrev_b32 v4, 6, v4
  v_add_u32 v23, v6, v4
  v_mov_b32 v168, 0
  v_mov_b32 v169, 0
  v_mov_b32 v170, 0
  v_mov_b32 v171, 0
  v_mov_b32 v172, 0
  v_mov_b32 v173, 0
  v_mov_b32 v174, 0
  v_mov_b32 v175, 0
  v_mov_b32 v176, 0
  v_mov_b32 v177, 0
  v_mov_b32 v178, 0
  v_mov_b32 v179, 0
  v_mov_b32 v180, 0
  v_mov_b32 v181, 0
  v_mov_b32 v182, 0
  v_mov_b32 v183, 0
  v_mov_b32 v184, 0
  v_mov_b32 v185, 0
  v_mov_b32 v186, 0
  v_mov_b32 v187, 0
  v_mov_b32 v188, 0
  v_mov_b32 v189, 0
  v_mov_b32 v190, 0
  v_mov_b32 v191, 0
  v_mov_b32 v192, 0
  v_mov_b32 v193, 0
  v_mov_b32 v194, 0
  v_mov_b32 v195, 0
  v_mov_b32 v196, 0
  v_mov_b32 v197, 0
  v_mov_b32 v198, 0
  v_mov_b32 v199, 0
  v_mov_b32 v200, 0
  v_mov_b32 v201, 0
  v_mov_b32 v202, 0
  v_mov_b32 v203, 0
  v_mov_b32 v204, 0
  v_mov_b32 v205, 0
  v_mov_b32 v206, 0
  v_mov_b32 v207, 0
  v_mov_b32 v208, 0
  v_mov_b32 v209, 0
  v_mov_b32 v210, 0
  v_mov_b32 v211, 0
  v_mov_b32 v212, 0
  v_mov_b32 v213, 0
  v_mov_b32 v214, 0
  v_mov_b32 v215, 0
  v_mov_b32 v216, 0
  v_mov_b32 v217, 0
  v_mov_b32 v218, 0
  v_mov_b32 v219, 0
  v_mov_b32 v220, 0
  v_mov_b32 v221, 0
  v_mov_b32 v222, 0
  v_mov_b32 v223, 0
  v_mov_b32 v224, 0
  v_mov_b32 v225, 0
  v_mov_b32 v226, 0
  v_mov_b32 v227, 0
  v_mov_b32 v228, 0
  v_mov_b32 v229, 0
  v_mov_b32 v230, 0
  v_mov_b32 v231, 0
  v_mov_b32 v32, 0
  v_mov_b32 v33, 0
  v_mov_b32 v34, 0
  v_mov_b32 v35, 0
  v_mov_b32 v36, 0
  v_mov_b32 v37, 0
  v_mov_b32 v38, 0
  v_mov_b32 v39, 0
  v_mov_b32 v40, 0
  v_mov_b32 v41, 0
  v_mov_b32 v42, 0
  v_mov_b32 v43, 0
  v_mov_b32 v44, 0
  v_mov_b32 v45, 0
  v_mov_b32 v46, 0
  v_mov_b32 v47, 0
  v_mov_b32 v25, 0
  s_mov_b32 s44, 0x49800000
  s_mov_b32 s42, 0
  v_mov_b32 v88, s80
  v_mov_b32 v89, s81
  v_mov_b32 v7, 0
  s_lshl_b32 s37, s23, 5
  s_lshl_b32 s38, s20, 3
  s_add_u32 s37, s37, s38
  s_add_u32 s37, s37, s54
  s_add_u32 s37, s37, 0x22080
  s_waitcnt vmcnt(0)
  s_mov_b64 exec, 1
  buffer_store_dwordx2 v[88:89], v7, s[24:27], s37 offen sc1
  s_barrier
  s_mov_b64 exec, -1
  s_lshl_b32 s34, s64, 13
  s_add_u32 m0, s36, 98304
  s_add_u32 s34, s34, s66
  buffer_load_dwordx4 v8, s[12:15], s34 offen nt lds
  buffer_load_dwordx4 v9, s[12:15], s34 offen offset:1024 nt lds
  s_add_u32 s64, s64, 1
  s_and_b32 s64, s64, 15
  s_lshl_b32 s35, s65, 13
  s_add_u32 m0, s36, 122880
  s_add_u32 s35, s35, s66
  buffer_load_dwordx4 v10, s[16:19], s35 offen nt lds
  buffer_load_dwordx4 v10, s[16:19], s35 offen offset:1024 nt lds
  s_add_u32 s65, s65, 1
  s_and_b32 s65, s65, 15
  s_mov_b32 m0, 156160
  s_mov_b32 s38, 0x4000000
  buffer_load_dwordx4 v11, s[56:59], s38 offen lds
  s_mov_b64 exec, 0xf
  v_lshlrev_b32 v7, 3, v0
  s_lshl_b32 s37, s20, 5
  s_add_u32 s37, s37, s54
  s_add_u32 s37, s37, 0x22080
  s_mov_b32 s41, 0
  buffer_load_dwordx2 v[136:137], v7, s[24:27], s37 offen sc1
  s_sleep 2
  buffer_load_dwordx2 v[138:139], v7, s[24:27], s37 offen sc1
  s_sleep 2
  buffer_load_dwordx2 v[140:141], v7, s[24:27], s37 offen sc1
  s_sleep 2
  buffer_load_dwordx2 v[142:143], v7, s[24:27], s37 offen sc1
POLL0:
  s_waitcnt vmcnt(3)
  v_cmp_ne_u64 vcc, s[80:81], v[136:137]
  s_cbranch_vccz POLL0_d
  buffer_load_dwordx2 v[136:137], v7, s[24:27], s37 offen sc1
  s_waitcnt vmcnt(3)
  v_cmp_ne_u64 vcc, s[80:81], v[138:139]
  s_cbranch_vccz POLL0_d
  buffer_load_dwordx2 v[138:139], v7, s[24:27], s37 offen sc1
  s_waitcnt vmcnt(3)
  v_cmp_ne_u64 vcc, s[80:81], v[140:141]
  s_cbranch_vccz POLL0_d
  buffer_load_dwordx2 v[140:141], v7, s[24:27], s37 offen sc1
  s_waitcnt vmcnt(3)
  v_cmp_ne_u64 vcc, s[80:81], v[142:143]
  s_cbranch_vccz POLL0_d
  buffer_load_dwordx2 v[142:143], v7, s[24:27], s37 offen sc1
  s_add_u32 s41, s41, 1
  s_cmp_lt_u32 s41, 0x10000
  s_cbranch_scc1 POLL0
POLL0_d:
  s_mov_b64 exec, -1
  s_lshl_b32 s33, s20, 13
  s_add_u32 s33, s33, s54
  s_add_u32 s33, s33, 0x23000
  s_add_u32 s37, s33, 4096
  buffer_load_dwordx4 a[0:3], v11, s[24:27], s33 offen offset:0 sc1
  buffer_load_dwordx4 a[4:7], v11, s[24:27], s33 offen offset:1024 sc1
  buffer_load_dwordx4 a[8:11], v11, s[24:27], s33 offen offset:2048 sc1
  buffer_load_dwordx4 a[12:15], v11, s[24:27], s33 offen offset:3072 sc1
  buffer_load_dwordx4 a[16:19], v11, s[24:27], s37 offen offset:0 sc1
  buffer_load_dwordx4 a[20:23], v11, s[24:27], s37 offen offset:1024 sc1
  buffer_load_dwordx4 a[24:27], v11, s[24:27], s37 offen offset:2048 sc1
  buffer_load_dwordx4 a[28:31], v11, s[24:27], s37 offen offset:3072 sc1
  s_lshl_b32 s34, s64, 13
  s_add_u32 m0, s36, 106496
  s_add_u32 s34, s34, s66
  buffer_load_dwordx4 v8, s[12:15], s34 offen nt lds
  buffer_load_dwordx4 v9, s[12:15], s34 offen offset:1024 nt lds
  s_add_u32 s64, s64, 1
  s_and_b32 s64, s64, 15
  s_lshl_b32 s35, s65, 13
  s_add_u32 m0, s36, 131072
  s_add_u32 s35, s35, s66
  buffer_load_dwordx4 v10, s[16:19], s35 offen nt lds
  buffer_load_dwordx4 v10, s[16:19], s35 offen offset:1024 nt lds
  s_add_u32 s65, s65, 1
  s_and_b32 s65, s65, 15
  s_mov_b32 m0, 156160
  s_mov_b32 s38, 0x4000000
  buffer_load_dwordx4 v11, s[56:59], s38 offen lds
  ds_read_b128 v[104:107], v12 offset:0
  ds_read_b128 v[108:111], v13 offset:0
  ds_read_b128 v[112:115], v14 offset:0
  ds_read_b128 v[116:119], v15 offset:0
  ds_read_b128 v[120:123], v16 offset:0
  ds_read_b128 v[124:127], v17 offset:0
  ds_read_b128 v[128:131], v18 offset:0
  ds_read_b128 v[132:135], v19 offset:0
  s_waitcnt vmcnt(5) lgkmcnt(0)
  v_mfma_f32_32x32x16_bf16 v[48:63], v[104:107], a[0:3], v[32:47]
  v_mfma_f32_32x32x16_bf16 v[48:63], v[108:111], a[4:7], v[48:63]
  v_mfma_f32_32x32x16_bf16 v[48:63], v[112:115], a[8:11], v[48:63]
  v_mfma_f32_32x32x16_bf16 v[48:63], v[116:119], a[12:15], v[48:63]
  v_mfma_f32_32x32x16_bf16 v[48:63], v[120:123], a[16:19], v[48:63]
  v_mfma_f32_32x32x16_bf16 v[48:63], v[124:127], a[20:23], v[48:63]
  v_mfma_f32_32x32x16_bf16 v[48:63], v[128:131], a[24:27], v[48:63]
  v_mfma_f32_32x32x16_bf16 v[48:63], v[132:135], a[28:31], v[48:63]
  s_barrier
  s_lshl_b32 s34, s64, 13
  s_add_u32 m0, s36, 81920
  s_add_u32 s34, s34, s66
  buffer_load_dwordx4 v8, s[12:15], s34 offen nt lds
  buffer_load_dwordx4 v9, s[12:15], s34 offen offset:1024 nt lds
  s_add_u32 s64, s64, 1
  s_and_b32 s64, s64, 15
  s_lshl_b32 s35, s65, 13
  s_add_u32 m0, s36, 139264
  s_add_u32 s35, s35, s66
  buffer_load_dwordx4 v10, s[16:19], s35 offen nt lds
  buffer_load_dwordx4 v10, s[16:19], s35 offen offset:1024 nt lds
  s_add_u32 s65, s65, 1
  s_and_b32 s65, s65, 15
  s_mov_b32 m0, 156160
  s_mov_b32 s38, 0x4000000
  buffer_load_dwordx4 v11, s[56:59], s38 offen lds
  ds_read_b128 v[104:107], v12 offset:8192
  ds_read_b128 v[108:111], v13 offset:8192
  ds_read_b128 v[112:115], v14 offset:8192
  ds_read_b128 v[116:119], v15 offset:8192
  ds_read_b128 v[120:123], v16 offset:8192
  ds_read_b128 v[124:127], v17 offset:8192
  ds_read_b128 v[128:131], v18 offset:8192
  ds_read_b128 v[132:135], v19 offset:8192
  ds_read_b64_tr_b16 v[136:137], v20 offset:0
  ds_read_b64_tr_b16 v[138:139], v20 offset:2048
  ds_read_b64_tr_b16 v[140:141], v21 offset:0
  ds_read_b64_tr_b16 v[142:143], v21 offset:2048
  ds_read_b64_tr_b16 v[144:145], v22 offset:0
  ds_read_b64_tr_b16 v[146:147], v22 offset:2048
  ds_read_b64_tr_b16 v[148:149], v23 offset:0
  ds_read_b64_tr_b16 v[150:151], v23 offset:2048
  ds_read_b64_tr_b16 v[152:153], v20 offset:4096
  ds_read_b64_tr_b16 v[154:155], v20 offset:6144
  ds_read_b64_tr_b16 v[156:157], v21 offset:4096
  ds_read_b64_tr_b16 v[158:159], v21 offset:6144
  ds_read_b64_tr_b16 v[160:161], v22 offset:4096
  ds_read_b64_tr_b16 v[162:163], v22 offset:6144
  ds_read_b64_tr_b16 v[164:165], v23 offset:4096
  ds_read_b64_tr_b16 v[166:167], v23 offset:6144
  v_max3_f32 v28, v48, v49, v50
  v_max3_f32 v28, v28, v51, v52
  v_max3_f32 v28, v28, v53, v54
  v_max3_f32 v28, v28, v55, v56
  v_max3_f32 v28, v28, v57, v58
  v_max3_f32 v28, v28, v59, v60
  v_max3_f32 v28, v28, v61, v62
  v_max_f32 v28, v28, v63
  v_mov_b32 v29, v28
  s_nop 1
  v_permlane32_swap_b32 v28, v29
  v_max_f32 v24, v28, v29
  v_sub_f32 v32, 0, v24
  v_sub_f32 v33, 0, v24
  v_sub_f32 v34, 0, v24
  v_sub_f32 v35, 0, v24
  v_sub_f32 v36, 0, v24
  v_sub_f32 v37, 0, v24
  v_sub_f32 v38, 0, v24
  v_sub_f32 v39, 0, v24
  v_sub_f32 v40, 0, v24
  v_sub_f32 v41, 0, v24
  v_sub_f32 v42, 0, v24
  v_sub_f32 v43, 0, v24
  v_sub_f32 v44, 0, v24
  v_sub_f32 v45, 0, v24
  v_sub_f32 v46, 0, v24
  v_sub_f32 v47, 0, v24
  v_sub_f32 v48, v48, v24
  v_sub_f32 v49, v49, v24
  v_sub_f32 v50, v50, v24
  v_sub_f32 v51, v51, v24
  v_sub_f32 v52, v52, v24
  v_sub_f32 v53, v53, v24
  v_sub_f32 v54, v54, v24
  v_sub_f32 v55, v55, v24
  v_sub_f32 v56, v56, v24
  v_sub_f32 v57, v57, v24
  v_sub_f32 v58, v58, v24
  v_sub_f32 v59, v59, v24
  v_sub_f32 v60, v60, v24
  v_sub_f32 v61, v61, v24
  v_sub_f32 v62, v62, v24
  v_sub_f32 v63, v63, v24
K2_loop:
  s_waitcnt lgkmcnt(10)
  v_mfma_f32_32x32x16_bf16 v[64:79], v[104:107], a[0:3], v[32:47]
  v_exp_f32 v80, v48
  v_exp_f32 v81, v49
  v_mfma_f32_32x32x16_bf16 v[64:79], v[108:111], a[4:7], v[64:79]
  v_exp_f32 v82, v50
  v_exp_f32 v83, v51
  v_cvt_pk_bf16_f32 v96, v80, v81
  v_mfma_f32_32x32x16_bf16 v[64:79], v[112:115], a[8:11], v[64:79]
  v_exp_f32 v84, v52
  v_exp_f32 v85, v53
  v_add_f32 v26, v80, v82
  v_add_f32 v27, v81, v83
  v_cvt_pk_bf16_f32 v97, v82, v83
  v_mfma_f32_32x32x16_bf16 v[64:79], v[116:119], a[12:15], v[64:79]
  v_exp_f32 v86, v54
  v_exp_f32 v87, v55
  v_add_f32 v26, v26, v84
  v_add_f32 v27, v27, v85
  v_cvt_pk_bf16_f32 v98, v84, v85
  v_mfma_f32_32x32x16_bf16 v[64:79], v[120:123], a[16:19], v[64:79]
  v_exp_f32 v88, v56
  v_exp_f32 v89, v57
  v_add_f32 v26, v26, v86
  v_add_f32 v27, v27, v87
  v_cvt_pk_bf16_f32 v99, v86, v87
  v_mfma_f32_32x32x16_bf16 v[64:79], v[124:127], a[20:23], v[64:79]
  v_exp_f32 v90, v58
  v_exp_f32 v91, v59
  v_add_f32 v26, v26, v88
  v_add_f32 v27, v27, v89
  v_cvt_pk_bf16_f32 v100, v88, v89
  v_mfma_f32_32x32x16_bf16 v[64:79], v[128:131], a[24:27], v[64:79]
  v_exp_f32 v92, v60
  v_exp_f32 v93, v61
  v_add_f32 v26, v26, v90
  v_add_f32 v27, v27, v91
  v_cvt_pk_bf16_f32 v101, v90, v91
  v_mfma_f32_32x32x16_bf16 v[64:79], v[132:135], a[28:31], v[64:79]
  v_exp_f32 v94, v62
  v_exp_f32 v95, v63
  v_add_f32 v26, v26, v92
  v_add_f32 v27, v27, v93
  v_cvt_pk_bf16_f32 v102, v92, v93
  v_add_f32 v26, v26, v94
  v_add_f32 v27, v27, v95
  v_cvt_pk_bf16_f32 v103, v94, v95
  v_add_f32 v26, v26, v27
  v_cmp_lt_f32 vcc, s44, v26
  s_cbranch_vccnz RARE0
RET0:
  v_add_f32 v25, v25, v26
  s_waitcnt vmcnt(11) lgkmcnt(0)
  s_barrier
  v_mfma_f32_32x32x16_bf16 v[168:183], v[136:139], v[96:99], v[168:183]
  ds_read_b128 v[104:107], v12 offset:16384
  ds_read_b128 v[108:111], v13 offset:16384
  ds_read_b64_tr_b16 v[136:137], v20 offset:8192
  ds_read_b64_tr_b16 v[138:139], v20 offset:10240
  s_lshl_b32 s34, s64, 13
  s_add_u32 m0, s36, 90112
  s_add_u32 s34, s34, s66
  v_mfma_f32_32x32x16_bf16 v[184:199], v[140:143], v[96:99], v[184:199]
  ds_read_b128 v[112:115], v14 offset:16384
  ds_read_b128 v[116:119], v15 offset:16384
  ds_read_b64_tr_b16 v[140:141], v21 offset:8192
  ds_read_b64_tr_b16 v[142:143], v21 offset:10240
  buffer_load_dwordx4 v8, s[12:15], s34 offen nt lds
  buffer_load_dwordx4 v9, s[12:15], s34 offen offset:1024 nt lds
  s_add_u32 s64, s64, 1
  v_mfma_f32_32x32x16_bf16 v[200:215], v[144:147], v[96:99], v[200:215]
  ds_read_b128 v[120:123], v16 offset:16384
  ds_read_b128 v[124:127], v17 offset:16384
  ds_read_b64_tr_b16 v[144:145], v22 offset:8192
  ds_read_b64_tr_b16 v[146:147], v22 offset:10240
  s_and_b32 s64, s64, 15
  s_lshl_b32 s35, s65, 13
  s_add_u32 m0, s36, 114688
  v_mfma_f32_32x32x16_bf16 v[216:231], v[148:151], v[96:99], v[216:231]
  ds_read_b128 v[128:131], v18 offset:16384
  ds_read_b128 v[132:135], v19 offset:16384
  ds_read_b64_tr_b16 v[148:149], v23 offset:8192
  ds_read_b64_tr_b16 v[150:151], v23 offset:10240
  s_add_u32 s35, s35, s66
  buffer_load_dwordx4 v10, s[16:19], s35 offen nt lds
  buffer_load_dwordx4 v10, s[16:19], s35 offen offset:1024 nt lds
  v_mfma_f32_32x32x16_bf16 v[168:183], v[152:155], v[100:103], v[168:183]
  ds_read_b64_tr_b16 v[152:153], v20 offset:12288
  ds_read_b64_tr_b16 v[154:155], v20 offset:14336
  s_add_u32 s65, s65, 1
  s_and_b32 s65, s65, 15
  s_mov_b32 m0, s49
  v_mfma_f32_32x32x16_bf16 v[184:199], v[156:159], v[100:103], v[184:199]
  ds_read_b64_tr_b16 v[156:157], v21 offset:12288
  ds_read_b64_tr_b16 v[158:159], v21 offset:14336
  s_add_u32 s49, s49, 4352
  buffer_load_dwordx4 v11, s[56:59], s48 offen lds
  s_add_u32 s48, s48, 4096
  v_mfma_f32_32x32x16_bf16 v[200:215], v[160:163], v[100:103], v[200:215]
  ds_read_b64_tr_b16 v[160:161], v22 offset:12288
  ds_read_b64_tr_b16 v[162:163], v22 offset:14336
  s_mov_b32 m0, s49
  s_add_u32 s49, s49, 4352
  buffer_load_dwordx4 v11, s[56:59], s48 offen lds
  v_mfma_f32_32x32x16_bf16 v[216:231], v[164:167], v[100:103], v[216:231]
  ds_read_b64_tr_b16 v[164:165], v23 offset:12288
  ds_read_b64_tr_b16 v[166:167], v23 offset:14336
  s_add_u32 s48, s48, 4096
  s_waitcnt lgkmcnt(10)
  v_mfma_f32_32x32x16_bf16 v[48:63], v[104:107], a[0:3], v[32:47]
  v_exp_f32 v80, v64
  v_exp_f32 v81, v65
  v_mfma_f32_32x32x16_bf16 v[48:63], v[108:111], a[4:7], v[48:63]
  v_exp_f32 v82, v66
  v_exp_f32 v83, v67
  v_cvt_pk_bf16_f32 v96, v80, v81
  v_mfma_f32_32x32x16_bf16 v[48:63], v[112:115], a[8:11], v[48:63]
  v_exp_f32 v84, v68
  v_exp_f32 v85, v69
  v_add_f32 v26, v80, v82
  v_add_f32 v27, v81, v83
  v_cvt_pk_bf16_f32 v97, v82, v83
  v_mfma_f32_32x32x16_bf16 v[48:63], v[116:119], a[12:15], v[48:63]
  v_exp_f32 v86, v70
  v_exp_f32 v87, v71
  v_add_f32 v26, v26, v84
  v_add_f32 v27, v27, v85
  v_cvt_pk_bf16_f32 v98, v84, v85
  v_mfma_f32_32x32x16_bf16 v[48:63], v[120:123], a[16:19], v[48:63]
  v_exp_f32 v88, v72
  v_exp_f32 v89, v73
  v_add_f32 v26, v26, v86
  v_add_f32 v27, v27, v87
  v_cvt_pk_bf16_f32 v99, v86, v87
  v_mfma_f32_32x32x16_bf16 v[48:63], v[124:127], a[20:23], v[48:63]
  v_exp_f32 v90, v74
  v_exp_f32 v91, v75
  v_add_f32 v26, v26, v88
  v_add_f32 v27, v27, v89
  v_cvt_pk_bf16_f32 v100, v88, v89
  v_mfma_f32_32x32x16_bf16 v[48:63], v[128:131], a[24:27], v[48:63]
  v_exp_f32 v92, v76
  v_exp_f32 v93, v77
  v_add_f32 v26, v26, v90
  v_add_f32 v27, v27, v91
  v_cvt_pk_bf16_f32 v101, v90, v91
  v_mfma_f32_32x32x16_bf16 v[48:63], v[132:135], a[28:31], v[48:63]
  v_exp_f32 v94, v78
  v_exp_f32 v95, v79
  v_add_f32 v26, v26, v92
  v_add_f32 v27, v27, v93
  v_cvt_pk_bf16_f32 v102, v92, v93
  v_add_f32 v26, v26, v94
  v_add_f32 v27, v27, v95
  v_cvt_pk_bf16_f32 v103, v94, v95
  v_add_f32 v26, v26, v27
  v_cmp_lt_f32 vcc, s44, v26
  s_cbranch_vccnz RARE1
RET1:
  v_add_f32 v25, v25, v26
  s_waitcnt vmcnt(12) lgkmcnt(0)
  s_barrier
  v_mfma_f32_32x32x16_bf16 v[168:183], v[136:139], v[96:99], v[168:183]
  ds_read_b128 v[104:107], v12 offset:24576
  ds_read_b128 v[108:111], v13 offset:24576
  ds_read_b64_tr_b16 v[136:137], v20 offset:16384
  ds_read_b64_tr_b16 v[138:139], v20 offset:18432
  s_lshl_b32 s34, s64, 13
  s_add_u32 m0, s36, 98304
  s_add_u32 s34, s34, s66
  v_mfma_f32_32x32x16_bf16 v[184:199], v[140:143], v[96:99], v[184:199]
  ds_read_b128 v[112:115], v14 offset:24576
  ds_read_b128 v[116:119], v15 offset:24576
  ds_read_b64_tr_b16 v[140:141], v21 offset:16384
  ds_read_b64_tr_b16 v[142:143], v21 offset:18432
  buffer_load_dwordx4 v8, s[12:15], s34 offen nt lds
  buffer_load_dwordx4 v9, s[12:15], s34 offen offset:1024 nt lds
  s_add_u32 s64, s64, 1
  v_mfma_f32_32x32x16_bf16 v[200:215], v[144:147], v[96:99], v[200:215]
  ds_read_b128 v[120:123], v16 offset:24576
  ds_read_b128 v[124:127], v17 offset:24576
  ds_read_b64_tr_b16 v[144:145], v22 offset:16384
  ds_read_b64_tr_b16 v[146:147], v22 offset:18432
  s_and_b32 s64, s64, 15
  s_lshl_b32 s35, s65, 13
  s_add_u32 m0, s36, 122880
  v_mfma_f32_32x32x16_bf16 v[216:231], v[148:151], v[96:99], v[216:231]
  ds_read_b128 v[128:131], v18 offset:24576
  ds_read_b128 v[132:135], v19 offset:24576
  ds_read_b64_tr_b16 v[148:149], v23 offset:16384
  ds_read_b64_tr_b16 v[150:151], v23 offset:18432
  s_add_u32 s35, s35, s66
  buffer_load_dwordx4 v10, s[16:19], s35 offen nt lds
  buffer_load_dwordx4 v10, s[16:19], s35 offen offset:1024 nt lds
  v_mfma_f32_32x32x16_bf16 v[168:183], v[152:155], v[100:103], v[168:183]
  ds_read_b64_tr_b16 v[152:153], v20 offset:20480
  ds_read_b64_tr_b16 v[154:155], v20 offset:22528
  s_add_u32 s65, s65, 1
  s_and_b32 s65, s65, 15
  s_mov_b32 m0, s49
  v_mfma_f32_32x32x16_bf16 v[184:199], v[156:159], v[100:103], v[184:199]
  ds_read_b64_tr_b16 v[156:157], v21 offset:20480
  ds_read_b64_tr_b16 v[158:159], v21 offset:22528
  s_add_u32 s49, s49, 4352
  buffer_load_dwordx4 v11, s[56:59], s48 offen lds
  s_add_u32 s48, s48, 4096
  v_mfma_f32_32x32x16_bf16 v[200:215], v[160:163], v[100:103], v[200:215]
  ds_read_b64_tr_b16 v[160:161], v22 offset:20480
  ds_read_b64_tr_b16 v[162:163], v22 offset:22528
  v_mfma_f32_32x32x16_bf16 v[216:231], v[164:167], v[100:103], v[216:231]
  ds_read_b64_tr_b16 v[164:165], v23 offset:20480
  ds_read_b64_tr_b16 v[166:167], v23 offset:22528
  s_waitcnt lgkmcnt(10)
  v_mfma_f32_32x32x16_bf16 v[64:79], v[104:107], a[0:3], v[32:47]
  v_exp_f32 v80, v48
  v_exp_f32 v81, v49
  v_mfma_f32_32x32x16_bf16 v[64:79], v[108:111], a[4:7], v[64:79]
  v_exp_f32 v82, v50
  v_exp_f32 v83, v51
  v_cvt_pk_bf16_f32 v96, v80, v81
  v_mfma_f32_32x32x16_bf16 v[64:79], v[112:115], a[8:11], v[64:79]
  v_exp_f32 v84, v52
  v_exp_f32 v85, v53
  v_add_f32 v26, v80, v82
  v_add_f32 v27, v81, v83
  v_cvt_pk_bf16_f32 v97, v82, v83
  v_mfma_f32_32x32x16_bf16 v[64:79], v[116:119], a[12:15], v[64:79]
  v_exp_f32 v86, v54
  v_exp_f32 v87, v55
  v_add_f32 v26, v26, v84
  v_add_f32 v27, v27, v85
  v_cvt_pk_bf16_f32 v98, v84, v85
  v_mfma_f32_32x32x16_bf16 v[64:79], v[120:123], a[16:19], v[64:79]
  v_exp_f32 v88, v56
  v_exp_f32 v89, v57
  v_add_f32 v26, v26, v86
  v_add_f32 v27, v27, v87
  v_cvt_pk_bf16_f32 v99, v86, v87
  v_mfma_f32_32x32x16_bf16 v[64:79], v[124:127], a[20:23], v[64:79]
  v_exp_f32 v90, v58
  v_exp_f32 v91, v59
  v_add_f32 v26, v26, v88
  v_add_f32 v27, v27, v89
  v_cvt_pk_bf16_f32 v100, v88, v89
  v_mfma_f32_32x32x16_bf16 v[64:79], v[128:131], a[24:27], v[64:79]
  v_exp_f32 v92, v60
  v_exp_f32 v93, v61
  v_add_f32 v26, v26, v90
  v_add_f32 v27, v27, v91
  v_cvt_pk_bf16_f32 v101, v90, v91
  v_mfma_f32_32x32x16_bf16 v[64:79], v[132:135], a[28:31], v[64:79]
  v_exp_f32 v94, v62
  v_exp_f32 v95, v63
  v_add_f32 v26, v26, v92
  v_add_f32 v27, v27, v93
  v_cvt_pk_bf16_f32 v102, v92, v93
  v_add_f32 v26, v26, v94
  v_add_f32 v27, v27, v95
  v_cvt_pk_bf16_f32 v103, v94, v95
  v_add_f32 v26, v26, v27
  v_cmp_lt_f32 vcc, s44, v26
  s_cbranch_vccnz RARE2
RET2:
  v_add_f32 v25, v25, v26
  s_waitcnt vmcnt(12) lgkmcnt(0)
  s_barrier
  v_mfma_f32_32x32x16_bf16 v[168:183], v[136:139], v[96:99], v[168:183]
  ds_read_b128 v[104:107], v12 offset:0
  ds_read_b128 v[108:111], v13 offset:0
  ds_read_b64_tr_b16 v[136:137], v20 offset:24576
  ds_read_b64_tr_b16 v[138:139], v20 offset:26624
  s_lshl_b32 s34, s64, 13
  s_add_u32 m0, s36, 106496
  s_add_u32 s34, s34, s66
  v_mfma_f32_32x32x16_bf16 v[184:199], v[140:143], v[96:99], v[184:199]
  ds_read_b128 v[112:115], v14 offset:0
  ds_read_b128 v[116:119], v15 offset:0
  ds_read_b64_tr_b16 v[140:141], v21 offset:24576
  ds_read_b64_tr_b16 v[142:143], v21 offset:26624
  buffer_load_dwordx4 v8, s[12:15], s34 offen nt lds
  buffer_load_dwordx4 v9, s[12:15], s34 offen offset:1024 nt lds
  s_add_u32 s64, s64, 1
  v_mfma_f32_32x32x16_bf16 v[200:215], v[144:147], v[96:99], v[200:215]
  ds_read_b128 v[120:123], v16 offset:0
  ds_read_b128 v[124:127], v17 offset:0
  ds_read_b64_tr_b16 v[144:145], v22 offset:24576
  ds_read_b64_tr_b16 v[146:147], v22 offset:26624
  s_and_b32 s64, s64, 15
  s_lshl_b32 s35, s65, 13
  s_add_u32 m0, s36, 131072
  v_mfma_f32_32x32x16_bf16 v[216:231], v[148:151], v[96:99], v[216:231]
  ds_read_b128 v[128:131], v18 offset:0
  ds_read_b128 v[132:135], v19 offset:0
  ds_read_b64_tr_b16 v[148:149], v23 offset:24576
  ds_read_b64_tr_b16 v[150:151], v23 offset:26624
  s_add_u32 s35, s35, s66
  buffer_load_dwordx4 v10, s[16:19], s35 offen nt lds
  buffer_load_dwordx4 v10, s[16:19], s35 offen offset:1024 nt lds
  v_mfma_f32_32x32x16_bf16 v[168:183], v[152:155], v[100:103], v[168:183]
  ds_read_b64_tr_b16 v[152:153], v20 offset:28672
  ds_read_b64_tr_b16 v[154:155], v20 offset:30720
  s_add_u32 s65, s65, 1
  s_and_b32 s65, s65, 15
  s_mov_b32 m0, s49
  v_mfma_f32_32x32x16_bf16 v[184:199], v[156:159], v[100:103], v[184:199]
  ds_read_b64_tr_b16 v[156:157], v21 offset:28672
  ds_read_b64_tr_b16 v[158:159], v21 offset:30720
  s_add_u32 s49, s49, 4352
  buffer_load_dwordx4 v11, s[56:59], s48 offen lds
  s_add_u32 s48, s48, 4096
  v_mfma_f32_32x32x16_bf16 v[200:215], v[160:163], v[100:103], v[200:215]
  ds_read_b64_tr_b16 v[160:161], v22 offset:28672
  ds_read_b64_tr_b16 v[162:163], v22 offset:30720
  v_mfma_f32_32x32x16_bf16 v[216:231], v[164:167], v[100:103], v[216:231]
  ds_read_b64_tr_b16 v[164:165], v23 offset:28672
  ds_read_b64_tr_b16 v[166:167], v23 offset:30720
  s_waitcnt lgkmcnt(10)
  v_mfma_f32_32x32x16_bf16 v[48:63], v[104:107], a[0:3], v[32:47]
  v_exp_f32 v80, v64
  v_exp_f32 v81, v65
  v_mfma_f32_32x32x16_bf16 v[48:63], v[108:111], a[4:7], v[48:63]
  v_exp_f32 v82, v66
  v_exp_f32 v83, v67
  v_cvt_pk_bf16_f32 v96, v80, v81
  v_mfma_f32_32x32x16_bf16 v[48:63], v[112:115], a[8:11], v[48:63]
  v_exp_f32 v84, v68
  v_exp_f32 v85, v69
  v_add_f32 v26, v80, v82
  v_add_f32 v27, v81, v83
  v_cvt_pk_bf16_f32 v97, v82, v83
  v_mfma_f32_32x32x16_bf16 v[48:63], v[116:119], a[12:15], v[48:63]
  v_exp_f32 v86, v70
  v_exp_f32 v87, v71
  v_add_f32 v26, v26, v84
  v_add_f32 v27, v27, v85
  v_cvt_pk_bf16_f32 v98, v84, v85
  v_mfma_f32_32x32x16_bf16 v[48:63], v[120:123], a[16:19], v[48:63]
  v_exp_f32 v88, v72
  v_exp_f32 v89, v73
  v_add_f32 v26, v26, v86
  v_add_f32 v27, v27, v87
  v_cvt_pk_bf16_f32 v99, v86, v87
  v_mfma_f32_32x32x16_bf16 v[48:63], v[124:127], a[20:23], v[48:63]
  v_exp_f32 v90, v74
  v_exp_f32 v91, v75
  v_add_f32 v26, v26, v88
  v_add_f32 v27, v27, v89
  v_cvt_pk_bf16_f32 v100, v88, v89
  v_mfma_f32_32x32x16_bf16 v[48:63], v[128:131], a[24:27], v[48:63]
  v_exp_f32 v92, v76
  v_exp_f32 v93, v77
  v_add_f32 v26, v26, v90
  v_add_f32 v27, v27, v91
  v_cvt_pk_bf16_f32 v101, v90, v91
  v_mfma_f32_32x32x16_bf16 v[48:63], v[132:135], a[28:31], v[48:63]
  v_exp_f32 v94, v78
  v_exp_f32 v95, v79
  v_add_f32 v26, v26, v92
  v_add_f32 v27, v27, v93
  v_cvt_pk_bf16_f32 v102, v92, v93
  v_add_f32 v26, v26, v94
  v_add_f32 v27, v27, v95
  v_cvt_pk_bf16_f32 v103, v94, v95
  v_add_f32 v26, v26, v27
  v_cmp_lt_f32 vcc, s44, v26
  s_cbranch_vccnz RARE3
RET3:
  v_add_f32 v25, v25, v26
  s_waitcnt vmcnt(12) lgkmcnt(0)
  s_barrier
  v_mfma_f32_32x32x16_bf16 v[168:183], v[136:139], v[96:99], v[168:183]
  ds_read_b128 v[104:107], v12 offset:8192
  ds_read_b128 v[108:111], v13 offset:8192
  ds_read_b64_tr_b16 v[136:137], v20 offset:0
  ds_read_b64_tr_b16 v[138:139], v20 offset:2048
  s_lshl_b32 s34, s64, 13
  s_add_u32 m0, s36, 81920
  s_add_u32 s34, s34, s66
  v_mfma_f32_32x32x16_bf16 v[184:199], v[140:143], v[96:99], v[184:199]
  ds_read_b128 v[112:115], v14 offset:8192
  ds_read_b128 v[116:119], v15 offset:8192
  ds_read_b64_tr_b16 v[140:141], v21 offset:0
  ds_read_b64_tr_b16 v[142:143], v21 offset:2048
  s_cmp_ge_u32 s42, 2
  s_cselect_b32 s34, 0x4000000, s34
  buffer_load_dwordx4 v8, s[12:15], s34 offen nt lds
  v_mfma_f32_32x32x16_bf16 v[200:215], v[144:147], v[96:99], v[200:215]
  ds_read_b128 v[120:123], v16 offset:8192
  ds_read_b128 v[124:127], v17 offset:8192
  ds_read_b64_tr_b16 v[144:145], v22 offset:0
  ds_read_b64_tr_b16 v[146:147], v22 offset:2048
  buffer_load_dwordx4 v9, s[12:15], s34 offen offset:1024 nt lds
  s_add_u32 s64, s64, 1
  s_and_b32 s64, s64, 15
  v_mfma_f32_32x32x16_bf16 v[216:231], v[148:151], v[96:99], v[216:231]
  ds_read_b128 v[128:131], v18 offset:8192
  ds_read_b128 v[132:135], v19 offset:8192
  ds_read_b64_tr_b16 v[148:149], v23 offset:0
  ds_read_b64_tr_b16 v[150:151], v23 offset:2048
  s_lshl_b32 s35, s65, 13
  s_add_u32 m0, s36, 139264
  s_add_u32 s35, s35, s66
  v_mfma_f32_32x32x16_bf16 v[168:183], v[152:155], v[100:103], v[168:183]
  ds_read_b64_tr_b16 v[152:153], v20 offset:4096
  ds_read_b64_tr_b16 v[154:155], v20 offset:6144
  buffer_load_dwordx4 v10, s[16:19], s35 offen nt lds
  buffer_load_dwordx4 v10, s[16:19], s35 offen offset:1024 nt lds
  s_add_u32 s65, s65, 1
  v_mfma_f32_32x32x16_bf16 v[184:199], v[156:159], v[100:103], v[184:199]
  ds_read_b64_tr_b16 v[156:157], v21 offset:4096
  ds_read_b64_tr_b16 v[158:159], v21 offset:6144
  s_and_b32 s65, s65, 15
  s_mov_b32 m0, s49
  s_add_u32 s49, s49, 4352
  v_mfma_f32_32x32x16_bf16 v[200:215], v[160:163], v[100:103], v[200:215]
  ds_read_b64_tr_b16 v[160:161], v22 offset:4096
  ds_read_b64_tr_b16 v[162:163], v22 offset:6144
  buffer_load_dwordx4 v11, s[56:59], s48 offen lds
  s_add_u32 s48, s48, 4096
  v_mfma_f32_32x32x16_bf16 v[216:231], v[164:167], v[100:103], v[216:231]
  ds_read_b64_tr_b16 v[164:165], v23 offset:4096
  ds_read_b64_tr_b16 v[166:167], v23 offset:6144
  s_add_u32 s42, s42, 1
  s_cmp_lt_u32 s42, 3
  s_cbranch_scc1 K2_loop
  s_waitcnt lgkmcnt(10)
  v_mfma_f32_32x32x16_bf16 v[64:79], v[104:107], a[0:3], v[32:47]
  v_exp_f32 v80, v48
  v_exp_f32 v81, v49
  v_mfma_f32_32x32x16_bf16 v[64:79], v[108:111], a[4:7], v[64:79]
  v_exp_f32 v82, v50
  v_exp_f32 v83, v51
  v_cvt_pk_bf16_f32 v96, v80, v81
  v_mfma_f32_32x32x16_bf16 v[64:79], v[112:115], a[8:11], v[64:79]
  v_exp_f32 v84, v52
  v_exp_f32 v85, v53
  v_add_f32 v26, v80, v82
  v_add_f32 v27, v81, v83
  v_cvt_pk_bf16_f32 v97, v82, v83
  v_mfma_f32_32x32x16_bf16 v[64:79], v[116:119], a[12:15], v[64:79]
  v_exp_f32 v86, v54
  v_exp_f32 v87, v55
  v_add_f32 v26, v26, v84
  v_add_f32 v27, v27, v85
  v_cvt_pk_bf16_f32 v98, v84, v85
  v_mfma_f32_32x32x16_bf16 v[64:79], v[120:123], a[16:19], v[64:79]
  v_exp_f32 v88, v56
  v_exp_f32 v89, v57
  v_add_f32 v26, v26, v86
  v_add_f32 v27, v27, v87
  v_cvt_pk_bf16_f32 v99, v86, v87
  v_mfma_f32_32x32x16_bf16 v[64:79], v[124:127], a[20:23], v[64:79]
  v_exp_f32 v90, v58
  v_exp_f32 v91, v59
  v_add_f32 v26, v26, v88
  v_add_f32 v27, v27, v89
  v_cvt_pk_bf16_f32 v100, v88, v89
  v_mfma_f32_32x32x16_bf16 v[64:79], v[128:131], a[24:27], v[64:79]
  v_exp_f32 v92, v60
  v_exp_f32 v93, v61
  v_add_f32 v26, v26, v90
  v_add_f32 v27, v27, v91
  v_cvt_pk_bf16_f32 v101, v90, v91
  v_mfma_f32_32x32x16_bf16 v[64:79], v[132:135], a[28:31], v[64:79]
  v_exp_f32 v94, v62
  v_exp_f32 v95, v63
  v_add_f32 v26, v26, v92
  v_add_f32 v27, v27, v93
  v_cvt_pk_bf16_f32 v102, v92, v93
  v_add_f32 v26, v26, v94
  v_add_f32 v27, v27, v95
  v_cvt_pk_bf16_f32 v103, v94, v95
  v_add_f32 v26, v26, v27
  v_cmp_lt_f32 vcc, s44, v26
  s_cbranch_vccnz RARE4
RET4:
  v_add_f32 v25, v25, v26
  s_waitcnt vmcnt(11) lgkmcnt(0)
  s_barrier
  v_mfma_f32_32x32x16_bf16 v[168:183], v[136:139], v[96:99], v[168:183]
  ds_read_b128 v[104:107], v12 offset:16384
  ds_read_b128 v[108:111], v13 offset:16384
  ds_read_b64_tr_b16 v[136:137], v20 offset:8192
  ds_read_b64_tr_b16 v[138:139], v20 offset:10240
  v_mfma_f32_32x32x16_bf16 v[184:199], v[140:143], v[96:99], v[184:199]
  ds_read_b128 v[112:115], v14 offset:16384
  ds_read_b128 v[116:119], v15 offset:16384
  ds_read_b64_tr_b16 v[140:141], v21 offset:8192
  ds_read_b64_tr_b16 v[142:143], v21 offset:10240
  v_mfma_f32_32x32x16_bf16 v[200:215], v[144:147], v[96:99], v[200:215]
  ds_read_b128 v[120:123], v16 offset:16384
  ds_read_b128 v[124:127], v17 offset:16384
  ds_read_b64_tr_b16 v[144:145], v22 offset:8192
  ds_read_b64_tr_b16 v[146:147], v22 offset:10240
  v_mfma_f32_32x32x16_bf16 v[216:231], v[148:151], v[96:99], v[216:231]
  ds_read_b128 v[128:131], v18 offset:16384
  ds_read_b128 v[132:135], v19 offset:16384
  ds_read_b64_tr_b16 v[148:149], v23 offset:8192
  ds_read_b64_tr_b16 v[150:151], v23 offset:10240
  v_mfma_f32_32x32x16_bf16 v[168:183], v[152:155], v[100:103], v[168:183]
  ds_read_b64_tr_b16 v[152:153], v20 offset:12288
  ds_read_b64_tr_b16 v[154:155], v20 offset:14336
  v_mfma_f32_32x32x16_bf16 v[184:199], v[156:159], v[100:103], v[184:199]
  ds_read_b64_tr_b16 v[156:157], v21 offset:12288
  ds_read_b64_tr_b16 v[158:159], v21 offset:14336
  v_mfma_f32_32x32x16_bf16 v[200:215], v[160:163], v[100:103], v[200:215]
  ds_read_b64_tr_b16 v[160:161], v22 offset:12288
  ds_read_b64_tr_b16 v[162:163], v22 offset:14336
  v_mfma_f32_32x32x16_bf16 v[216:231], v[164:167], v[100:103], v[216:231]
  ds_read_b64_tr_b16 v[164:165], v23 offset:12288
  ds_read_b64_tr_b16 v[166:167], v23 offset:14336
  s_waitcnt lgkmcnt(10)
  v_mfma_f32_32x32x16_bf16 v[48:63], v[104:107], a[0:3], v[32:47]
  v_exp_f32 v80, v64
  v_exp_f32 v81, v65
  v_mfma_f32_32x32x16_bf16 v[48:63], v[108:111], a[4:7], v[48:63]
  v_exp_f32 v82, v66
  v_exp_f32 v83, v67
  v_cvt_pk_bf16_f32 v96, v80, v81
  v_mfma_f32_32x32x16_bf16 v[48:63], v[112:115], a[8:11], v[48:63]
  v_exp_f32 v84, v68
  v_exp_f32 v85, v69
  v_add_f32 v26, v80, v82
  v_add_f32 v27, v81, v83
  v_cvt_pk_bf16_f32 v97, v82, v83
  v_mfma_f32_32x32x16_bf16 v[48:63], v[116:119], a[12:15], v[48:63]
  v_exp_f32 v86, v70
  v_exp_f32 v87, v71
  v_add_f32 v26, v26, v84
  v_add_f32 v27, v27, v85
  v_cvt_pk_bf16_f32 v98, v84, v85
  v_mfma_f32_32x32x16_bf16 v[48:63], v[120:123], a[16:19], v[48:63]
  v_exp_f32 v88, v72
  v_exp_f32 v89, v73
  v_add_f32 v26, v26, v86
  v_add_f32 v27, v27, v87
  v_cvt_pk_bf16_f32 v99, v86, v87
  v_mfma_f32_32x32x16_bf16 v[48:63], v[124:127], a[20:23], v[48:63]
  v_exp_f32 v90, v74
  v_exp_f32 v91, v75
  v_add_f32 v26, v26, v88
  v_add_f32 v27, v27, v89
  v_cvt_pk_bf16_f32 v100, v88, v89
  v_mfma_f32_32x32x16_bf16 v[48:63], v[128:131], a[24:27], v[48:63]
  v_exp_f32 v92, v76
  v_exp_f32 v93, v77
  v_add_f32 v26, v26, v90
  v_add_f32 v27, v27, v91
  v_cvt_pk_bf16_f32 v101, v90, v91
  v_mfma_f32_32x32x16_bf16 v[48:63], v[132:135], a[28:31], v[48:63]
  v_exp_f32 v94, v78
  v_exp_f32 v95, v79
  v_add_f32 v26, v26, v92
  v_add_f32 v27, v27, v93
  v_cvt_pk_bf16_f32 v102, v92, v93
  v_add_f32 v26, v26, v94
  v_add_f32 v27, v27, v95
  v_cvt_pk_bf16_f32 v103, v94, v95
  v_add_f32 v26, v26, v27
  v_cmp_lt_f32 vcc, s44, v26
  s_cbranch_vccnz RARE5
RET5:
  v_add_f32 v25, v25, v26
  s_waitcnt vmcnt(6) lgkmcnt(0)
  s_barrier
  v_mfma_f32_32x32x16_bf16 v[168:183], v[136:139], v[96:99], v[168:183]
  ds_read_b128 v[104:107], v12 offset:24576
  ds_read_b128 v[108:111], v13 offset:24576
  ds_read_b64_tr_b16 v[136:137], v20 offset:16384
  ds_read_b64_tr_b16 v[138:139], v20 offset:18432
  v_mfma_f32_32x32x16_bf16 v[184:199], v[140:143], v[96:99], v[184:199]
  ds_read_b128 v[112:115], v14 offset:24576
  ds_read_b128 v[116:119], v15 offset:24576
  ds_read_b64_tr_b16 v[140:141], v21 offset:16384
  ds_read_b64_tr_b16 v[142:143], v21 offset:18432
  v_mfma_f32_32x32x16_bf16 v[200:215], v[144:147], v[96:99], v[200:215]
  ds_read_b128 v[120:123], v16 offset:24576
  ds_read_b128 v[124:127], v17 offset:24576
  ds_read_b64_tr_b16 v[144:145], v22 offset:16384
  ds_read_b64_tr_b16 v[146:147], v22 offset:18432
  v_mfma_f32_32x32x16_bf16 v[216:231], v[148:151], v[96:99], v[216:231]
  ds_read_b128 v[128:131], v18 offset:24576
  ds_read_b128 v[132:135], v19 offset:24576
  ds_read_b64_tr_b16 v[148:149], v23 offset:16384
  ds_read_b64_tr_b16 v[150:151], v23 offset:18432
  v_mfma_f32_32x32x16_bf16 v[168:183], v[152:155], v[100:103], v[168:183]
  ds_read_b64_tr_b16 v[152:153], v20 offset:20480
  ds_read_b64_tr_b16 v[154:155], v20 offset:22528
  v_mfma_f32_32x32x16_bf16 v[184:199], v[156:159], v[100:103], v[184:199]
  ds_read_b64_tr_b16 v[156:157], v21 offset:20480
  ds_read_b64_tr_b16 v[158:159], v21 offset:22528
  v_mfma_f32_32x32x16_bf16 v[200:215], v[160:163], v[100:103], v[200:215]
  ds_read_b64_tr_b16 v[160:161], v22 offset:20480
  ds_read_b64_tr_b16 v[162:163], v22 offset:22528
  v_mfma_f32_32x32x16_bf16 v[216:231], v[164:167], v[100:103], v[216:231]
  ds_read_b64_tr_b16 v[164:165], v23 offset:20480
  ds_read_b64_tr_b16 v[166:167], v23 offset:22528
  s_waitcnt lgkmcnt(10)
  v_mfma_f32_32x32x16_bf16 v[64:79], v[104:107], a[0:3], v[32:47]
  v_exp_f32 v80, v48
  v_exp_f32 v81, v49
  v_mfma_f32_32x32x16_bf16 v[64:79], v[108:111], a[4:7], v[64:79]
  v_exp_f32 v82, v50
  v_exp_f32 v83, v51
  v_cvt_pk_bf16_f32 v96, v80, v81
  v_mfma_f32_32x32x16_bf16 v[64:79], v[112:115], a[8:11], v[64:79]
  v_exp_f32 v84, v52
  v_exp_f32 v85, v53
  v_add_f32 v26, v80, v82
  v_add_f32 v27, v81, v83
  v_cvt_pk_bf16_f32 v97, v82, v83
  v_mfma_f32_32x32x16_bf16 v[64:79], v[116:119], a[12:15], v[64:79]
  v_exp_f32 v86, v54
  v_exp_f32 v87, v55
  v_add_f32 v26, v26, v84
  v_add_f32 v27, v27, v85
  v_cvt_pk_bf16_f32 v98, v84, v85
  v_mfma_f32_32x32x16_bf16 v[64:79], v[120:123], a[16:19], v[64:79]
  v_exp_f32 v88, v56
  v_exp_f32 v89, v57
  v_add_f32 v26, v26, v86
  v_add_f32 v27, v27, v87
  v_cvt_pk_bf16_f32 v99, v86, v87
  v_mfma_f32_32x32x16_bf16 v[64:79], v[124:127], a[20:23], v[64:79]
  v_exp_f32 v90, v58
  v_exp_f32 v91, v59
  v_add_f32 v26, v26, v88
  v_add_f32 v27, v27, v89
  v_cvt_pk_bf16_f32 v100, v88, v89
  v_mfma_f32_32x32x16_bf16 v[64:79], v[128:131], a[24:27], v[64:79]
  v_exp_f32 v92, v60
  v_exp_f32 v93, v61
  v_add_f32 v26, v26, v90
  v_add_f32 v27, v27, v91
  v_cvt_pk_bf16_f32 v101, v90, v91
  v_mfma_f32_32x32x16_bf16 v[64:79], v[132:135], a[28:31], v[64:79]
  v_exp_f32 v94, v62
  v_exp_f32 v95, v63
  v_add_f32 v26, v26, v92
  v_add_f32 v27, v27, v93
  v_cvt_pk_bf16_f32 v102, v92, v93
  v_add_f32 v26, v26, v94
  v_add_f32 v27, v27, v95
  v_cvt_pk_bf16_f32 v103, v94, v95
  v_add_f32 v26, v26, v27
  v_cmp_lt_f32 vcc, s44, v26
  s_cbranch_vccnz RARE6
RET6:
  v_add_f32 v25, v25, v26
  s_waitcnt lgkmcnt(0)
  v_mfma_f32_32x32x16_bf16 v[168:183], v[136:139], v[96:99], v[168:183]
  v_mfma_f32_32x32x16_bf16 v[184:199], v[140:143], v[96:99], v[184:199]
  v_mfma_f32_32x32x16_bf16 v[200:215], v[144:147], v[96:99], v[200:215]
  v_mfma_f32_32x32x16_bf16 v[216:231], v[148:151], v[96:99], v[216:231]
  v_mfma_f32_32x32x16_bf16 v[168:183], v[152:155], v[100:103], v[168:183]
  v_mfma_f32_32x32x16_bf16 v[184:199], v[156:159], v[100:103], v[184:199]
  v_mfma_f32_32x32x16_bf16 v[200:215], v[160:163], v[100:103], v[200:215]
  v_mfma_f32_32x32x16_bf16 v[216:231], v[164:167], v[100:103], v[216:231]
  v_exp_f32 v80, v64
  v_exp_f32 v81, v65
  v_exp_f32 v82, v66
  v_exp_f32 v83, v67
  v_cvt_pk_bf16_f32 v96, v80, v81
  v_exp_f32 v84, v68
  v_exp_f32 v85, v69
  v_add_f32 v26, v80, v82
  v_add_f32 v27, v81, v83
  v_cvt_pk_bf16_f32 v97, v82, v83
  v_exp_f32 v86, v70
  v_exp_f32 v87, v71
  v_add_f32 v26, v26, v84
  v_add_f32 v27, v27, v85
  v_cvt_pk_bf16_f32 v98, v84, v85
  v_exp_f32 v88, v72
  v_exp_f32 v89, v73
  v_add_f32 v26, v26, v86
  v_add_f32 v27, v27, v87
  v_cvt_pk_bf16_f32 v99, v86, v87
  v_exp_f32 v90, v74
  v_exp_f32 v91, v75
  v_add_f32 v26, v26, v88
  v_add_f32 v27, v27, v89
  v_cvt_pk_bf16_f32 v100, v88, v89
  v_exp_f32 v92, v76
  v_exp_f32 v93, v77
  v_add_f32 v26, v26, v90
  v_add_f32 v27, v27, v91
  v_cvt_pk_bf16_f32 v101, v90, v91
  v_exp_f32 v94, v78
  v_exp_f32 v95, v79
  v_add_f32 v26, v26, v92
  v_add_f32 v27, v27, v93
  v_cvt_pk_bf16_f32 v102, v92, v93
  v_add_f32 v26, v26, v94
  v_add_f32 v27, v27, v95
  v_cvt_pk_bf16_f32 v103, v94, v95
  v_add_f32 v26, v26, v27
  v_cmp_lt_f32 vcc, s44, v26
  s_cbranch_vccnz RARE7
RET7:
  v_add_f32 v25, v25, v26
  s_waitcnt vmcnt(0)
  s_barrier
  ds_read_b64_tr_b16 v[136:137], v20 offset:24576
  ds_read_b64_tr_b16 v[138:139], v20 offset:26624
  ds_read_b64_tr_b16 v[152:153], v20 offset:28672
  ds_read_b64_tr_b16 v[154:155], v20 offset:30720
  ds_read_b64_tr_b16 v[140:141], v21 offset:24576
  ds_read_b64_tr_b16 v[142:143], v21 offset:26624
  ds_read_b64_tr_b16 v[156:157], v21 offset:28672
  ds_read_b64_tr_b16 v[158:159], v21 offset:30720
  ds_read_b64_tr_b16 v[144:145], v22 offset:24576
  ds_read_b64_tr_b16 v[146:147], v22 offset:26624
  ds_read_b64_tr_b16 v[160:161], v22 offset:28672
  ds_read_b64_tr_b16 v[162:163], v22 offset:30720
  ds_read_b64_tr_b16 v[148:149], v23 offset:24576
  ds_read_b64_tr_b16 v[150:151], v23 offset:26624
  ds_read_b64_tr_b16 v[164:165], v23 offset:28672
  ds_read_b64_tr_b16 v[166:167], v23 offset:30720
  v_mov_b32 v28, v25
  s_lshl_b32 s46, s20, 15
  s_lshl_b32 s37, s23, 13
  s_add_u32 s46, s46, s37
  s_add_u32 s46, s46, s54
  v_permlane32_swap_b32 v25, v28
  s_lshl_b32 s37, s20, 11
  s_lshl_b32 s38, s23, 9
  s_add_u32 s37, s37, s38
  s_add_u32 s37, s37, s54
  s_add_u32 s37, s37, 0x20000
  v_add_f32 v25, v25, v28
  v_mov_b32 v26, 0
  v_mov_b32 v27, 0
  s_mov_b32 s12, s24
  s_mov_b32 s13, s25
  s_mov_b32 s15, 0x20000
  s_cmp_eq_u32 s20, s23
  s_cselect_b32 s14, 0, 0x10000000
  v_cmp_gt_u32 vcc, 32, v0
  s_and_saveexec_b64 s[50:51], vcc
  buffer_store_dwordx4 v[24:27], v11, s[12:15], s37 offen sc1
  s_mov_b64 exec, s[50:51]
  s_add_u32 s38, s46, 4096
  s_waitcnt lgkmcnt(12)
  s_nop 1
  v_mfma_f32_32x32x16_bf16 v[168:183], v[136:139], v[96:99], v[168:183]
  v_mfma_f32_32x32x16_bf16 v[168:183], v[152:155], v[100:103], v[168:183]
  s_waitcnt lgkmcnt(8)
  v_mfma_f32_32x32x16_bf16 v[184:199], v[140:143], v[96:99], v[184:199]
  v_mfma_f32_32x32x16_bf16 v[184:199], v[156:159], v[100:103], v[184:199]
  s_nop 8
  v_cvt_pk_bf16_f32 v104, v168, v169
  v_cvt_pk_bf16_f32 v105, v170, v171
  v_cvt_pk_bf16_f32 v106, v172, v173
  v_cvt_pk_bf16_f32 v107, v174, v175
  buffer_store_dwordx4 v[104:107], v11, s[12:15], s46 offen offset:0 sc1
  v_cvt_pk_bf16_f32 v108, v176, v177
  v_cvt_pk_bf16_f32 v109, v178, v179
  v_cvt_pk_bf16_f32 v110, v180, v181
  v_cvt_pk_bf16_f32 v111, v182, v183
  buffer_store_dwordx4 v[108:111], v11, s[12:15], s46 offen offset:1024 sc1
  s_waitcnt lgkmcnt(4)
  v_mfma_f32_32x32x16_bf16 v[200:215], v[144:147], v[96:99], v[200:215]
  v_mfma_f32_32x32x16_bf16 v[200:215], v[160:163], v[100:103], v[200:215]
  v_cvt_pk_bf16_f32 v112, v184, v185
  v_cvt_pk_bf16_f32 v113, v186, v187
  v_cvt_pk_bf16_f32 v114, v188, v189
  v_cvt_pk_bf16_f32 v115, v190, v191
  buffer_store_dwordx4 v[112:115], v11, s[12:15], s46 offen offset:2048 sc1
  v_cvt_pk_bf16_f32 v116, v192, v193
  v_cvt_pk_bf16_f32 v117, v194, v195
  v_cvt_pk_bf16_f32 v118, v196, v197
  v_cvt_pk_bf16_f32 v119, v198, v199
  buffer_store_dwordx4 v[116:119], v11, s[12:15], s46 offen offset:3072 sc1
  s_waitcnt lgkmcnt(0)
  v_mfma_f32_32x32x16_bf16 v[216:231], v[148:151], v[96:99], v[216:231]
  v_mfma_f32_32x32x16_bf16 v[216:231], v[164:167], v[100:103], v[216:231]
  v_cvt_pk_bf16_f32 v120, v200, v201
  v_cvt_pk_bf16_f32 v121, v202, v203
  v_cvt_pk_bf16_f32 v122, v204, v205
  v_cvt_pk_bf16_f32 v123, v206, v207
  buffer_store_dwordx4 v[120:123], v11, s[12:15], s38 offen offset:0 sc1
  v_cvt_pk_bf16_f32 v124, v208, v209
  v_cvt_pk_bf16_f32 v125, v210, v211
  v_cvt_pk_bf16_f32 v126, v212, v213
  v_cvt_pk_bf16_f32 v127, v214, v215
  buffer_store_dwordx4 v[124:127], v11, s[12:15], s38 offen offset:1024 sc1
  s_nop 1
  v_cvt_pk_bf16_f32 v128, v216, v217
  v_cvt_pk_bf16_f32 v129, v218, v219
  v_cvt_pk_bf16_f32 v130, v220, v221
  v_cvt_pk_bf16_f32 v131, v222, v223
  buffer_store_dwordx4 v[128:131], v11, s[12:15], s38 offen offset:2048 sc1
  v_cvt_pk_bf16_f32 v132, v224, v225
  v_cvt_pk_bf16_f32 v133, v226, v227
  v_cvt_pk_bf16_f32 v134, v228, v229
  v_cvt_pk_bf16_f32 v135, v230, v231
  buffer_store_dwordx4 v[132:135], v11, s[12:15], s38 offen offset:3072 sc1
  s_cmp_lg_u32 s20, s23
  s_cbranch_scc1 K2_nown
  v_add_u32 v1, 147456, v11
  ds_write_b128 v1, v[104:107] offset:0
  ds_write_b128 v1, v[108:111] offset:1024
  ds_write_b128 v1, v[112:115] offset:2048
  ds_write_b128 v1, v[116:119] offset:3072
  ds_write_b128 v1, v[120:123] offset:4096
  ds_write_b128 v1, v[124:127] offset:5120
  ds_write_b128 v1, v[128:131] offset:6144
  ds_write_b128 v1, v[132:135] offset:7168
  v_cmp_gt_u32 vcc, 32, v0
  s_and_saveexec_b64 s[50:51], vcc
  ds_write_b128 v1, v[24:27] offset:8192
  s_mov_b64 exec, s[50:51]
K2_nown:
  s_barrier
  s_lshl_b32 s40, s20, 5
  s_lshl_b32 s38, s23, 3
  s_add_u32 s40, s40, s38
  s_add_u32 s40, s40, s54
  s_add_u32 s40, s40, 0x22000
  v_mov_b32 v4, s80
  v_mov_b32 v5, s81
  v_mov_b32 v2, 0
  s_waitcnt vmcnt(0)
  s_mov_b64 exec, 1
  buffer_store_dwordx2 v[4:5], v2, s[12:15], s40 offen sc1
  s_mov_b64 exec, -1
  s_mov_b32 m0, s49
  s_add_u32 s49, s49, 4352
  buffer_load_dwordx4 v11, s[56:59], s48 offen lds
  s_add_u32 s48, s48, 4096
  s_mov_b32 m0, s49
  s_add_u32 s49, s49, 4352
  buffer_load_dwordx4 v11, s[56:59], s48 offen lds
  s_add_u32 s48, s48, 4096
  s_mov_b32 m0, s49
  s_add_u32 s49, s49, 4352
  buffer_load_dwordx4 v11, s[56:59], s48 offen lds
  s_add_u32 s48, s48, 4096
  s_mov_b32 m0, s49
  s_add_u32 s49, s49, 4352
  buffer_load_dwordx4 v11, s[56:59], s48 offen lds
  s_add_u32 s48, s48, 4096
  s_mov_b32 m0, s49
  s_add_u32 s49, s49, 4352
  buffer_load_dwordx4 v11, s[56:59], s48 offen lds
  s_add_u32 s48, s48, 4096
  s_mov_b32 m0, s49
  s_add_u32 s49, s49, 4352
  buffer_load_dwordx4 v11, s[56:59], s48 offen lds
  s_add_u32 s48, s48, 4096
  s_mov_b32 m0, s49
  s_add_u32 s49, s49, 4352
  buffer_load_dwordx4 v11, s[56:59], s48 offen lds
  s_add_u32 s48, s48, 4096
  s_mov_b32 m0, s49
  s_add_u32 s49, s49, 4352
  buffer_load_dwordx4 v11, s[56:59], s48 offen lds
  s_add_u32 s48, s48, 4096
  s_mov_b32 m0, s49
  s_add_u32 s49, s49, 4352
  buffer_load_dwordx4 v11, s[56:59], s48 offen lds
  s_add_u32 s48, s48, 4096
  s_mov_b32 m0, s49
  s_add_u32 s49, s49, 4352
  buffer_load_dwordx4 v11, s[56:59], s48 offen lds
  s_add_u32 s48, s48, 4096
  s_mov_b32 m0, s49
  s_add_u32 s49, s49, 4352
  buffer_load_dwordx4 v11, s[56:59], s48 offen lds
  s_add_u32 s48, s48, 4096
  s_mov_b32 m0, s49
  s_add_u32 s49, s49, 4352
  buffer_load_dwordx4 v11, s[56:59], s48 offen lds
  s_add_u32 s48, s48, 4096
  s_mov_b32 m0, s49
  s_add_u32 s49, s49, 4352
  buffer_load_dwordx4 v11, s[56:59], s48 offen lds
  s_add_u32 s48, s48, 4096
  s_mov_b32 m0, s49
  s_add_u32 s49, s49, 4352
  buffer_load_dwordx4 v11, s[56:59], s48 offen lds
  s_add_u32 s48, s48, 4096
  s_mov_b32 m0, s49
  s_add_u32 s49, s49, 4352
  buffer_load_dwordx4 v11, s[56:59], s48 offen lds
  s_add_u32 s48, s48, 4096
  s_mov_b32 m0, s49
  s_add_u32 s49, s49, 4352
  buffer_load_dwordx4 v11, s[56:59], s48 offen lds
  s_add_u32 s48, s48, 4096
  s_mov_b32 m0, s49
  s_add_u32 s49, s49, 4352
  buffer_load_dwordx4 v11, s[56:59], s48 offen lds
  s_add_u32 s48, s48, 4096
  s_cmp_lg_u32 s20, 0
  s_cbranch_scc1 K2_nopoll
  s_lshl_b32 s40, s23, 5
  s_add_u32 s40, s40, s54
  s_add_u32 s40, s40, 0x22000
  v_lshlrev_b32 v7, 3, v0
  s_lshl_b32 s38, 1, s23
  s_andn2_b32 s38, 0xf, s38
  s_mov_b32 s39, 0
  s_mov_b64 exec, s[38:39]
  s_mov_b32 s41, 0
  buffer_load_dwordx2 v[12:13], v7, s[24:27], s40 offen sc1
  s_sleep 2
  buffer_load_dwordx2 v[14:15], v7, s[24:27], s40 offen sc1
  s_sleep 2
  buffer_load_dwordx2 v[16:17], v7, s[24:27], s40 offen sc1
  s_sleep 2
  buffer_load_dwordx2 v[18:19], v7, s[24:27], s40 offen sc1
K2_poll:
  s_waitcnt vmcnt(3)
  v_cmp_ne_u64 vcc, s[80:81], v[12:13]
  s_cbranch_vccz K2_poll_d
  buffer_load_dwordx2 v[12:13], v7, s[24:27], s40 offen sc1
  s_waitcnt vmcnt(3)
  v_cmp_ne_u64 vcc, s[80:81], v[14:15]
  s_cbranch_vccz K2_poll_d
  buffer_load_dwordx2 v[14:15], v7, s[24:27], s40 offen sc1
  s_waitcnt vmcnt(3)
  v_cmp_ne_u64 vcc, s[80:81], v[16:17]
  s_cbranch_vccz K2_poll_d
  buffer_load_dwordx2 v[16:17], v7, s[24:27], s40 offen sc1
  s_waitcnt vmcnt(3)
  v_cmp_ne_u64 vcc, s[80:81], v[18:19]
  s_cbranch_vccz K2_poll_d
  buffer_load_dwordx2 v[18:19], v7, s[24:27], s40 offen sc1
  s_add_u32 s41, s41, 1
  s_cmp_lt_u32 s41, 0x10000
  s_cbranch_scc1 K2_poll
K2_poll_d:
  s_mov_b64 exec, -1
K2_nopoll:
  s_waitcnt lgkmcnt(0)
  s_barrier
  v_and_b32 v3, 31, v0
  v_lshlrev_b32 v3, 4, v3
  s_lshl_b32 s37, s23, 11
  s_add_u32 s37, s37, s54
  s_add_u32 s37, s37, 0x20000
  s_lshl_b32 s46, s23, 15
  s_add_u32 s46, s46, s54
  s_add_u32 s46, s46, s36
  s_add_u32 s38, s23, 1
  s_and_b32 s38, s38, 3
  s_lshl_b32 s39, s38, 9
  s_add_u32 s39, s39, s37
  buffer_load_dwordx4 v[36:39], v3, s[24:27], s39 offen sc1
  s_add_u32 s38, s23, 2
  s_and_b32 s38, s38, 3
  s_lshl_b32 s39, s38, 9
  s_add_u32 s39, s39, s37
  buffer_load_dwordx4 v[40:43], v3, s[24:27], s39 offen sc1
  s_add_u32 s38, s23, 3
  s_and_b32 s38, s38, 3
  s_lshl_b32 s39, s38, 9
  s_add_u32 s39, s39, s37
  buffer_load_dwordx4 v[44:47], v3, s[24:27], s39 offen sc1
  s_add_u32 s38, s23, 1
  s_and_b32 s38, s38, 3
  s_lshl_b32 s39, s38, 13
  s_add_u32 s39, s39, s46
  buffer_load_dwordx4 v[72:75], v11, s[24:27], s39 offen offset:0 sc1
  buffer_load_dwordx4 v[76:79], v11, s[24:27], s39 offen offset:1024 sc1
  s_add_u32 s38, s23, 2
  s_and_b32 s38, s38, 3
  s_lshl_b32 s39, s38, 13
  s_add_u32 s39, s39, s46
  buffer_load_dwordx4 v[80:83], v11, s[24:27], s39 offen offset:0 sc1
  buffer_load_dwordx4 v[84:87], v11, s[24:27], s39 offen offset:1024 sc1
  s_add_u32 s38, s23, 3
  s_and_b32 s38, s38, 3
  s_lshl_b32 s39, s38, 13
  s_add_u32 s39, s39, s46
  buffer_load_dwordx4 v[88:91], v11, s[24:27], s39 offen offset:0 sc1
  buffer_load_dwordx4 v[92:95], v11, s[24:27], s39 offen offset:1024 sc1
  v_add_u32 v1, 155648, v3
  ds_read_b128 v[32:35], v1
  s_add_u32 s39, s36, 147456
  v_add_u32 v1, s39, v11
  ds_read_b128 v[64:67], v1
  ds_read_b128 v[68:71], v1 offset:1024
  v_and_b32 v4, 15, v0
  v_lshrrev_b32 v4, 2, v4
  v_lshrrev_b32 v5, 5, v0
  v_lshlrev_b32 v5, 2, v5
  v_add_u32 v4, v4, v5
  v_mul_u32_u24 v4, 1088, v4
  v_lshrrev_b32 v5, 4, v0
  v_and_b32 v5, 1, v5
  v_lshlrev_b32 v5, 5, v5
  v_add_u32 v4, v4, v5
  v_and_b32 v5, 3, v0
  v_lshlrev_b32 v5, 3, v5
  v_add_u32 v4, v4, v5
  s_lshl_b32 s38, s20, 8
  v_add_u32 v4, s38, v4
  v_add_u32 v5, 69632, v4
  s_waitcnt vmcnt(6) lgkmcnt(0)
  v_max3_f32 v16, v32, v36, v40
  v_max_f32 v16, v16, v44
  v_sub_f32 v32, v32, v16
  v_sub_f32 v36, v36, v16
  v_sub_f32 v40, v40, v16
  v_sub_f32 v44, v44, v16
  v_exp_f32 v32, v32
  v_exp_f32 v36, v36
  v_exp_f32 v40, v40
  v_exp_f32 v44, v44
  v_mul_f32 v17, v32, v33
  v_fmac_f32 v17, v36, v37
  v_fmac_f32 v17, v40, v41
  v_fmac_f32 v17, v44, v45
  v_rcp_f32 v17, v17
  s_nop 0
  v_mul_f32 v32, v32, v17
  v_mul_f32 v36, v36, v17
  v_mul_f32 v40, v40, v17
  v_mul_f32 v44, v44, v17
  s_mov_b32 s40, 0xffff0000
  s_waitcnt vmcnt(0)
  v_lshlrev_b32 v18, 16, v64
  v_and_b32 v19, s40, v64
  v_mul_f32 v20, v18, v32
  v_mul_f32 v21, v19, v32
  v_lshlrev_b32 v18, 16, v72
  v_and_b32 v19, s40, v72
  v_fmac_f32 v20, v18, v36
  v_fmac_f32 v21, v19, v36
  v_lshlrev_b32 v18, 16, v80
  v_and_b32 v19, s40, v80
  v_fmac_f32 v20, v18, v40
  v_fmac_f32 v21, v19, v40
  v_lshlrev_b32 v18, 16, v88
  v_and_b32 v19, s40, v88
  v_fmac_f32 v20, v18, v44
  v_fmac_f32 v21, v19, v44
  v_cvt_pk_bf16_f32 v24, v20, v21
  v_lshlrev_b32 v18, 16, v65
  v_and_b32 v19, s40, v65
  v_mul_f32 v20, v18, v32
  v_mul_f32 v21, v19, v32
  v_lshlrev_b32 v18, 16, v73
  v_and_b32 v19, s40, v73
  v_fmac_f32 v20, v18, v36
  v_fmac_f32 v21, v19, v36
  v_lshlrev_b32 v18, 16, v81
  v_and_b32 v19, s40, v81
  v_fmac_f32 v20, v18, v40
  v_fmac_f32 v21, v19, v40
  v_lshlrev_b32 v18, 16, v89
  v_and_b32 v19, s40, v89
  v_fmac_f32 v20, v18, v44
  v_fmac_f32 v21, v19, v44
  v_cvt_pk_bf16_f32 v25, v20, v21
  v_lshlrev_b32 v18, 16, v66
  v_and_b32 v19, s40, v66
  v_mul_f32 v20, v18, v32
  v_mul_f32 v21, v19, v32
  v_lshlrev_b32 v18, 16, v74
  v_and_b32 v19, s40, v74
  v_fmac_f32 v20, v18, v36
  v_fmac_f32 v21, v19, v36
  v_lshlrev_b32 v18, 16, v82
  v_and_b32 v19, s40, v82
  v_fmac_f32 v20, v18, v40
  v_fmac_f32 v21, v19, v40
  v_lshlrev_b32 v18, 16, v90
  v_and_b32 v19, s40, v90
  v_fmac_f32 v20, v18, v44
  v_fmac_f32 v21, v19, v44
  v_cvt_pk_bf16_f32 v26, v20, v21
  v_lshlrev_b32 v18, 16, v67
  v_and_b32 v19, s40, v67
  v_mul_f32 v20, v18, v32
  v_mul_f32 v21, v19, v32
  v_lshlrev_b32 v18, 16, v75
  v_and_b32 v19, s40, v75
  v_fmac_f32 v20, v18, v36
  v_fmac_f32 v21, v19, v36
  v_lshlrev_b32 v18, 16, v83
  v_and_b32 v19, s40, v83
  v_fmac_f32 v20, v18, v40
  v_fmac_f32 v21, v19, v40
  v_lshlrev_b32 v18, 16, v91
  v_and_b32 v19, s40, v91
  v_fmac_f32 v20, v18, v44
  v_fmac_f32 v21, v19, v44
  v_cvt_pk_bf16_f32 v27, v20, v21
  v_lshlrev_b32 v18, 16, v68
  v_and_b32 v19, s40, v68
  v_mul_f32 v20, v18, v32
  v_mul_f32 v21, v19, v32
  v_lshlrev_b32 v18, 16, v76
  v_and_b32 v19, s40, v76
  v_fmac_f32 v20, v18, v36
  v_fmac_f32 v21, v19, v36
  v_lshlrev_b32 v18, 16, v84
  v_and_b32 v19, s40, v84
  v_fmac_f32 v20, v18, v40
  v_fmac_f32 v21, v19, v40
  v_lshlrev_b32 v18, 16, v92
  v_and_b32 v19, s40, v92
  v_fmac_f32 v20, v18, v44
  v_fmac_f32 v21, v19, v44
  v_cvt_pk_bf16_f32 v28, v20, v21
  v_lshlrev_b32 v18, 16, v69
  v_and_b32 v19, s40, v69
  v_mul_f32 v20, v18, v32
  v_mul_f32 v21, v19, v32
  v_lshlrev_b32 v18, 16, v77
  v_and_b32 v19, s40, v77
  v_fmac_f32 v20, v18, v36
  v_fmac_f32 v21, v19, v36
  v_lshlrev_b32 v18, 16, v85
  v_and_b32 v19, s40, v85
  v_fmac_f32 v20, v18, v40
  v_fmac_f32 v21, v19, v40
  v_lshlrev_b32 v18, 16, v93
  v_and_b32 v19, s40, v93
  v_fmac_f32 v20, v18, v44
  v_fmac_f32 v21, v19, v44
  v_cvt_pk_bf16_f32 v29, v20, v21
  v_lshlrev_b32 v18, 16, v70
  v_and_b32 v19, s40, v70
  v_mul_f32 v20, v18, v32
  v_mul_f32 v21, v19, v32
  v_lshlrev_b32 v18, 16, v78
  v_and_b32 v19, s40, v78
  v_fmac_f32 v20, v18, v36
  v_fmac_f32 v21, v19, v36
  v_lshlrev_b32 v18, 16, v86
  v_and_b32 v19, s40, v86
  v_fmac_f32 v20, v18, v40
  v_fmac_f32 v21, v19, v40
  v_lshlrev_b32 v18, 16, v94
  v_and_b32 v19, s40, v94
  v_fmac_f32 v20, v18, v44
  v_fmac_f32 v21, v19, v44
  v_cvt_pk_bf16_f32 v30, v20, v21
  v_lshlrev_b32 v18, 16, v71
  v_and_b32 v19, s40, v71
  v_mul_f32 v20, v18, v32
  v_mul_f32 v21, v19, v32
  v_lshlrev_b32 v18, 16, v79
  v_and_b32 v19, s40, v79
  v_fmac_f32 v20, v18, v36
  v_fmac_f32 v21, v19, v36
  v_lshlrev_b32 v18, 16, v87
  v_and_b32 v19, s40, v87
  v_fmac_f32 v20, v18, v40
  v_fmac_f32 v21, v19, v40
  v_lshlrev_b32 v18, 16, v95
  v_and_b32 v19, s40, v95
  v_fmac_f32 v20, v18, v44
  v_fmac_f32 v21, v19, v44
  v_cvt_pk_bf16_f32 v31, v20, v21
  s_add_u32 s39, s36, 139264
  v_add_u32 v6, s39, v11
  ds_write_b128 v6, v[24:27]
  ds_write_b128 v6, v[28:31] offset:1024
  v_add_u32 v6, 139264, v11
  s_waitcnt lgkmcnt(0)
  s_barrier
  ds_read_b128 v[32:35], v6 offset:0
  ds_read_b128 v[36:39], v6 offset:1024
  ds_read_b128 v[40:43], v6 offset:2048
  ds_read_b128 v[44:47], v6 offset:3072
  ds_read_b128 v[48:51], v6 offset:4096
  ds_read_b128 v[52:55], v6 offset:5120
  ds_read_b128 v[56:59], v6 offset:6144
  ds_read_b128 v[60:63], v6 offset:7168
  s_lshl_b32 s34, s20, 18
  s_lshl_b32 s35, s47, 10
  s_add_u32 s34, s34, s35
  s_add_u32 s34, s34, s55
  ds_read_b64_tr_b16 v[64:65], v4 offset:0
  ds_read_b64_tr_b16 v[66:67], v4 offset:8704
  ds_read_b64_tr_b16 v[68:69], v4 offset:17408
  ds_read_b64_tr_b16 v[70:71], v4 offset:26112
  ds_read_b64_tr_b16 v[72:73], v4 offset:34816
  ds_read_b64_tr_b16 v[74:75], v4 offset:43520
  ds_read_b64_tr_b16 v[76:77], v4 offset:52224
  ds_read_b64_tr_b16 v[78:79], v4 offset:60928
  ds_read_b64_tr_b16 v[80:81], v5 offset:0
  ds_read_b64_tr_b16 v[82:83], v5 offset:8704
  ds_read_b64_tr_b16 v[84:85], v5 offset:17408
  ds_read_b64_tr_b16 v[86:87], v5 offset:26112
  s_waitcnt lgkmcnt(10)
  v_mfma_f32_32x32x16_bf16 v[168:183], v[64:67], v[32:35], 0
  ds_read_b64_tr_b16 v[88:89], v5 offset:34816
  ds_read_b64_tr_b16 v[90:91], v5 offset:43520
  s_waitcnt lgkmcnt(10)
  v_mfma_f32_32x32x16_bf16 v[168:183], v[68:71], v[36:39], v[168:183]
  ds_read_b64_tr_b16 v[92:93], v5 offset:52224
  ds_read_b64_tr_b16 v[94:95], v5 offset:60928
  s_waitcnt lgkmcnt(10)
  v_mfma_f32_32x32x16_bf16 v[168:183], v[72:75], v[40:43], v[168:183]
  ds_read_b64_tr_b16 v[64:65], v4 offset:64
  ds_read_b64_tr_b16 v[66:67], v4 offset:8768
  s_waitcnt lgkmcnt(10)
  v_mfma_f32_32x32x16_bf16 v[168:183], v[76:79], v[44:47], v[168:183]
  ds_read_b64_tr_b16 v[68:69], v4 offset:17472
  ds_read_b64_tr_b16 v[70:71], v4 offset:26176
  s_waitcnt lgkmcnt(10)
  v_mfma_f32_32x32x16_bf16 v[168:183], v[80:83], v[48:51], v[168:183]
  ds_read_b64_tr_b16 v[72:73], v4 offset:34880
  ds_read_b64_tr_b16 v[74:75], v4 offset:43584
  s_waitcnt lgkmcnt(10)
  v_mfma_f32_32x32x16_bf16 v[168:183], v[84:87], v[52:55], v[168:183]
  ds_read_b64_tr_b16 v[76:77], v4 offset:52288
  ds_read_b64_tr_b16 v[78:79], v4 offset:60992
  s_waitcnt lgkmcnt(10)
  v_mfma_f32_32x32x16_bf16 v[168:183], v[88:91], v[56:59], v[168:183]
  ds_read_b64_tr_b16 v[80:81], v5 offset:64
  ds_read_b64_tr_b16 v[82:83], v5 offset:8768
  s_waitcnt lgkmcnt(10)
  v_mfma_f32_32x32x16_bf16 v[168:183], v[92:95], v[60:63], v[168:183]
  ds_read_b64_tr_b16 v[84:85], v5 offset:17472
  ds_read_b64_tr_b16 v[86:87], v5 offset:26176
  s_waitcnt lgkmcnt(10)
  v_mfma_f32_32x32x16_bf16 v[184:199], v[64:67], v[32:35], 0
  ds_read_b64_tr_b16 v[88:89], v5 offset:34880
  ds_read_b64_tr_b16 v[90:91], v5 offset:43584
  s_waitcnt lgkmcnt(10)
  v_mfma_f32_32x32x16_bf16 v[184:199], v[68:71], v[36:39], v[184:199]
  ds_read_b64_tr_b16 v[92:93], v5 offset:52288
  ds_read_b64_tr_b16 v[94:95], v5 offset:60992
  s_waitcnt lgkmcnt(10)
  v_mfma_f32_32x32x16_bf16 v[184:199], v[72:75], v[40:43], v[184:199]
  ds_read_b64_tr_b16 v[64:65], v4 offset:128
  ds_read_b64_tr_b16 v[66:67], v4 offset:8832
  v_cvt_pk_bf16_f32 v96, v168, v169
  v_cvt_pk_bf16_f32 v97, v170, v171
  v_cvt_pk_bf16_f32 v98, v172, v173
  v_cvt_pk_bf16_f32 v99, v174, v175
  buffer_store_dwordx4 v[96:99], v11, s[24:27], s34 offen sc1
  s_add_u32 s34, s34, 0x8000
  v_cvt_pk_bf16_f32 v100, v176, v177
  v_cvt_pk_bf16_f32 v101, v178, v179
  v_cvt_pk_bf16_f32 v102, v180, v181
  v_cvt_pk_bf16_f32 v103, v182, v183
  buffer_store_dwordx4 v[100:103], v11, s[24:27], s34 offen sc1
  s_add_u32 s34, s34, 0x8000
  s_waitcnt lgkmcnt(10)
  v_mfma_f32_32x32x16_bf16 v[184:199], v[76:79], v[44:47], v[184:199]
  ds_read_b64_tr_b16 v[68:69], v4 offset:17536
  ds_read_b64_tr_b16 v[70:71], v4 offset:26240
  s_waitcnt lgkmcnt(10)
  v_mfma_f32_32x32x16_bf16 v[184:199], v[80:83], v[48:51], v[184:199]
  ds_read_b64_tr_b16 v[72:73], v4 offset:34944
  ds_read_b64_tr_b16 v[74:75], v4 offset:43648
  s_waitcnt lgkmcnt(10)
  v_mfma_f32_32x32x16_bf16 v[184:199], v[84:87], v[52:55], v[184:199]
  ds_read_b64_tr_b16 v[76:77], v4 offset:52352
  ds_read_b64_tr_b16 v[78:79], v4 offset:61056
  s_waitcnt lgkmcnt(10)
  v_mfma_f32_32x32x16_bf16 v[184:199], v[88:91], v[56:59], v[184:199]
  ds_read_b64_tr_b16 v[80:81], v5 offset:128
  ds_read_b64_tr_b16 v[82:83], v5 offset:8832
  s_waitcnt lgkmcnt(10)
  v_mfma_f32_32x32x16_bf16 v[184:199], v[92:95], v[60:63], v[184:199]
  ds_read_b64_tr_b16 v[84:85], v5 offset:17536
  ds_read_b64_tr_b16 v[86:87], v5 offset:26240
  s_waitcnt lgkmcnt(10)
  v_mfma_f32_32x32x16_bf16 v[200:215], v[64:67], v[32:35], 0
  ds_read_b64_tr_b16 v[88:89], v5 offset:34944
  ds_read_b64_tr_b16 v[90:91], v5 offset:43648
  s_waitcnt lgkmcnt(10)
  v_mfma_f32_32x32x16_bf16 v[200:215], v[68:71], v[36:39], v[200:215]
  ds_read_b64_tr_b16 v[92:93], v5 offset:52352
  ds_read_b64_tr_b16 v[94:95], v5 offset:61056
  s_waitcnt lgkmcnt(10)
  v_mfma_f32_32x32x16_bf16 v[200:215], v[72:75], v[40:43], v[200:215]
  ds_read_b64_tr_b16 v[64:65], v4 offset:192
  ds_read_b64_tr_b16 v[66:67], v4 offset:8896
  v_cvt_pk_bf16_f32 v104, v184, v185
  v_cvt_pk_bf16_f32 v105, v186, v187
  v_cvt_pk_bf16_f32 v106, v188, v189
  v_cvt_pk_bf16_f32 v107, v190, v191
  buffer_store_dwordx4 v[104:107], v11, s[24:27], s34 offen sc1
  s_add_u32 s34, s34, 0x8000
  v_cvt_pk_bf16_f32 v108, v192, v193
  v_cvt_pk_bf16_f32 v109, v194, v195
  v_cvt_pk_bf16_f32 v110, v196, v197
  v_cvt_pk_bf16_f32 v111, v198, v199
  buffer_store_dwordx4 v[108:111], v11, s[24:27], s34 offen sc1
  s_add_u32 s34, s34, 0x8000
  s_waitcnt lgkmcnt(10)
  v_mfma_f32_32x32x16_bf16 v[200:215], v[76:79], v[44:47], v[200:215]
  ds_read_b64_tr_b16 v[68:69], v4 offset:17600
  ds_read_b64_tr_b16 v[70:71], v4 offset:26304
  s_waitcnt lgkmcnt(10)
  v_mfma_f32_32x32x16_bf16 v[200:215], v[80:83], v[48:51], v[200:215]
  ds_read_b64_tr_b16 v[72:73], v4 offset:35008
  ds_read_b64_tr_b16 v[74:75], v4 offset:43712
  s_waitcnt lgkmcnt(10)
  v_mfma_f32_32x32x16_bf16 v[200:215], v[84:87], v[52:55], v[200:215]
  ds_read_b64_tr_b16 v[76:77], v4 offset:52416
  ds_read_b64_tr_b16 v[78:79], v4 offset:61120
  s_waitcnt lgkmcnt(10)
  v_mfma_f32_32x32x16_bf16 v[200:215], v[88:91], v[56:59], v[200:215]
  ds_read_b64_tr_b16 v[80:81], v5 offset:192
  ds_read_b64_tr_b16 v[82:83], v5 offset:8896
  s_waitcnt lgkmcnt(10)
  v_mfma_f32_32x32x16_bf16 v[200:215], v[92:95], v[60:63], v[200:215]
  ds_read_b64_tr_b16 v[84:85], v5 offset:17600
  ds_read_b64_tr_b16 v[86:87], v5 offset:26304
  s_waitcnt lgkmcnt(10)
  v_mfma_f32_32x32x16_bf16 v[216:231], v[64:67], v[32:35], 0
  ds_read_b64_tr_b16 v[88:89], v5 offset:35008
  ds_read_b64_tr_b16 v[90:91], v5 offset:43712
  s_waitcnt lgkmcnt(10)
  v_mfma_f32_32x32x16_bf16 v[216:231], v[68:71], v[36:39], v[216:231]
  ds_read_b64_tr_b16 v[92:93], v5 offset:52416
  ds_read_b64_tr_b16 v[94:95], v5 offset:61120
  s_waitcnt lgkmcnt(10)
  v_mfma_f32_32x32x16_bf16 v[216:231], v[72:75], v[40:43], v[216:231]
  v_cvt_pk_bf16_f32 v96, v200, v201
  v_cvt_pk_bf16_f32 v97, v202, v203
  v_cvt_pk_bf16_f32 v98, v204, v205
  v_cvt_pk_bf16_f32 v99, v206, v207
  buffer_store_dwordx4 v[96:99], v11, s[24:27], s34 offen sc1
  s_add_u32 s34, s34, 0x8000
  v_cvt_pk_bf16_f32 v100, v208, v209
  v_cvt_pk_bf16_f32 v101, v210, v211
  v_cvt_pk_bf16_f32 v102, v212, v213
  v_cvt_pk_bf16_f32 v103, v214, v215
  buffer_store_dwordx4 v[100:103], v11, s[24:27], s34 offen sc1
  s_add_u32 s34, s34, 0x8000
  s_waitcnt lgkmcnt(8)
  v_mfma_f32_32x32x16_bf16 v[216:231], v[76:79], v[44:47], v[216:231]
  s_waitcnt lgkmcnt(6)
  v_mfma_f32_32x32x16_bf16 v[216:231], v[80:83], v[48:51], v[216:231]
  s_waitcnt lgkmcnt(4)
  v_mfma_f32_32x32x16_bf16 v[216:231], v[84:87], v[52:55], v[216:231]
  s_waitcnt lgkmcnt(2)
  v_mfma_f32_32x32x16_bf16 v[216:231], v[88:91], v[56:59], v[216:231]
  s_waitcnt lgkmcnt(0)
  v_mfma_f32_32x32x16_bf16 v[216:231], v[92:95], v[60:63], v[216:231]
  s_nop 11
  v_cvt_pk_bf16_f32 v104, v216, v217
  v_cvt_pk_bf16_f32 v105, v218, v219
  v_cvt_pk_bf16_f32 v106, v220, v221
  v_cvt_pk_bf16_f32 v107, v222, v223
  buffer_store_dwordx4 v[104:107], v11, s[24:27], s34 offen sc1
  s_add_u32 s34, s34, 0x8000
  v_cvt_pk_bf16_f32 v108, v224, v225
  v_cvt_pk_bf16_f32 v109, v226, v227
  v_cvt_pk_bf16_f32 v110, v228, v229
  v_cvt_pk_bf16_f32 v111, v230, v231
  buffer_store_dwordx4 v[108:111], v11, s[24:27], s34 offen sc1
  s_add_u32 s34, s34, 0x8000
  s_lshl_b32 s40, s20, 11
  s_lshl_b32 s38, s47, 3
  s_add_u32 s40, s40, s38
  s_add_u32 s40, s40, s55
  s_add_u32 s40, s40, 0x100000
  v_mov_b32 v4, s80
  v_mov_b32 v5, s81
  v_lshlrev_b32 v2, 8, v0
  s_waitcnt vmcnt(0)
  s_mov_b64 exec, 0xff
  buffer_store_dwordx2 v[4:5], v2, s[24:27], s40 offen sc1
  s_mov_b64 exec, -1
  s_cmp_lg_u32 s20, 0
  s_cbranch_scc1 K2_polled2
  s_lshl_b32 s40, s47, 8
  s_add_u32 s40, s40, s55
  s_add_u32 s40, s40, 0x100000
  v_lshlrev_b32 v7, 3, v0
  s_mov_b32 s38, -1
  s_mov_b32 s39, 0
  s_mov_b64 exec, s[38:39]
  s_mov_b32 s41, 0
  buffer_load_dwordx2 v[12:13], v7, s[24:27], s40 offen sc1
  s_sleep 2
  buffer_load_dwordx2 v[14:15], v7, s[24:27], s40 offen sc1
  s_sleep 2
  buffer_load_dwordx2 v[16:17], v7, s[24:27], s40 offen sc1
  s_sleep 2
  buffer_load_dwordx2 v[18:19], v7, s[24:27], s40 offen sc1
K2_poll2:
  s_waitcnt vmcnt(3)
  v_cmp_ne_u64 vcc, s[80:81], v[12:13]
  s_cbranch_vccz K2_poll2_d
  buffer_load_dwordx2 v[12:13], v7, s[24:27], s40 offen sc1
  s_waitcnt vmcnt(3)
  v_cmp_ne_u64 vcc, s[80:81], v[14:15]
  s_cbranch_vccz K2_poll2_d
  buffer_load_dwordx2 v[14:15], v7, s[24:27], s40 offen sc1
  s_waitcnt vmcnt(3)
  v_cmp_ne_u64 vcc, s[80:81], v[16:17]
  s_cbranch_vccz K2_poll2_d
  buffer_load_dwordx2 v[16:17], v7, s[24:27], s40 offen sc1
  s_waitcnt vmcnt(3)
  v_cmp_ne_u64 vcc, s[80:81], v[18:19]
  s_cbranch_vccz K2_poll2_d
  buffer_load_dwordx2 v[18:19], v7, s[24:27], s40 offen sc1
  s_add_u32 s41, s41, 1
  s_cmp_lt_u32 s41, 0x10000
  s_cbranch_scc1 K2_poll2
K2_poll2_d:
  s_mov_b64 exec, -1
K2_polled2:
  s_barrier
  s_lshl_b32 s30, s47, 15
  s_lshl_b32 s31, s20, 13
  s_add_u32 s30, s30, s31
  s_add_u32 s30, s30, s55
  buffer_load_dwordx4 v[32:35], v11, s[24:27], s30 offen offset:0 sc1
  buffer_load_dwordx4 v[36:39], v11, s[24:27], s30 offen offset:1024 sc1
  buffer_load_dwordx4 v[40:43], v11, s[24:27], s30 offen offset:2048 sc1
  buffer_load_dwordx4 v[44:47], v11, s[24:27], s30 offen offset:3072 sc1
  s_add_u32 s30, s30, 4096
  buffer_load_dwordx4 v[48:51], v11, s[24:27], s30 offen offset:0 sc1
  buffer_load_dwordx4 v[52:55], v11, s[24:27], s30 offen offset:1024 sc1
  buffer_load_dwordx4 v[56:59], v11, s[24:27], s30 offen offset:2048 sc1
  buffer_load_dwordx4 v[60:63], v11, s[24:27], s30 offen offset:3072 sc1
  s_mov_b32 s40, 0xffff0000
  v_add_u32 v3, s36, v11
  s_waitcnt vmcnt(7)
  v_lshlrev_b32 v64, 16, v32
  v_and_b32 v65, s40, v32
  v_lshlrev_b32 v66, 16, v33
  v_and_b32 v67, s40, v33
  v_lshlrev_b32 v68, 16, v34
  v_and_b32 v69, s40, v34
  v_lshlrev_b32 v70, 16, v35
  v_and_b32 v71, s40, v35
  s_waitcnt vmcnt(6)
  v_lshlrev_b32 v4, 16, v36
  v_and_b32 v5, s40, v36
  v_add_f32 v64, v64, v4
  v_add_f32 v65, v65, v5
  v_lshlrev_b32 v4, 16, v37
  v_and_b32 v5, s40, v37
  v_add_f32 v66, v66, v4
  v_add_f32 v67, v67, v5
  v_lshlrev_b32 v4, 16, v38
  v_and_b32 v5, s40, v38
  v_add_f32 v68, v68, v4
  v_add_f32 v69, v69, v5
  v_lshlrev_b32 v4, 16, v39
  v_and_b32 v5, s40, v39
  v_add_f32 v70, v70, v4
  v_add_f32 v71, v71, v5
  s_waitcnt vmcnt(5)
  v_lshlrev_b32 v4, 16, v40
  v_and_b32 v5, s40, v40
  v_add_f32 v64, v64, v4
  v_add_f32 v65, v65, v5
  v_lshlrev_b32 v4, 16, v41
  v_and_b32 v5, s40, v41
  v_add_f32 v66, v66, v4
  v_add_f32 v67, v67, v5
  v_lshlrev_b32 v4, 16, v42
  v_and_b32 v5, s40, v42
  v_add_f32 v68, v68, v4
  v_add_f32 v69, v69, v5
  v_lshlrev_b32 v4, 16, v43
  v_and_b32 v5, s40, v43
  v_add_f32 v70, v70, v4
  v_add_f32 v71, v71, v5
  s_waitcnt vmcnt(4)
  v_lshlrev_b32 v4, 16, v44
  v_and_b32 v5, s40, v44
  v_add_f32 v64, v64, v4
  v_add_f32 v65, v65, v5
  v_lshlrev_b32 v4, 16, v45
  v_and_b32 v5, s40, v45
  v_add_f32 v66, v66, v4
  v_add_f32 v67, v67, v5
  v_lshlrev_b32 v4, 16, v46
  v_and_b32 v5, s40, v46
  v_add_f32 v68, v68, v4
  v_add_f32 v69, v69, v5
  v_lshlrev_b32 v4, 16, v47
  v_and_b32 v5, s40, v47
  v_add_f32 v70, v70, v4
  v_add_f32 v71, v71, v5
  s_waitcnt vmcnt(3)
  v_lshlrev_b32 v4, 16, v48
  v_and_b32 v5, s40, v48
  v_add_f32 v64, v64, v4
  v_add_f32 v65, v65, v5
  v_lshlrev_b32 v4, 16, v49
  v_and_b32 v5, s40, v49
  v_add_f32 v66, v66, v4
  v_add_f32 v67, v67, v5
  v_lshlrev_b32 v4, 16, v50
  v_and_b32 v5, s40, v50
  v_add_f32 v68, v68, v4
  v_add_f32 v69, v69, v5
  v_lshlrev_b32 v4, 16, v51
  v_and_b32 v5, s40, v51
  v_add_f32 v70, v70, v4
  v_add_f32 v71, v71, v5
  s_waitcnt vmcnt(2)
  v_lshlrev_b32 v4, 16, v52
  v_and_b32 v5, s40, v52
  v_add_f32 v64, v64, v4
  v_add_f32 v65, v65, v5
  v_lshlrev_b32 v4, 16, v53
  v_and_b32 v5, s40, v53
  v_add_f32 v66, v66, v4
  v_add_f32 v67, v67, v5
  v_lshlrev_b32 v4, 16, v54
  v_and_b32 v5, s40, v54
  v_add_f32 v68, v68, v4
  v_add_f32 v69, v69, v5
  v_lshlrev_b32 v4, 16, v55
  v_and_b32 v5, s40, v55
  v_add_f32 v70, v70, v4
  v_add_f32 v71, v71, v5
  s_waitcnt vmcnt(1)
  v_lshlrev_b32 v4, 16, v56
  v_and_b32 v5, s40, v56
  v_add_f32 v64, v64, v4
  v_add_f32 v65, v65, v5
  v_lshlrev_b32 v4, 16, v57
  v_and_b32 v5, s40, v57
  v_add_f32 v66, v66, v4
  v_add_f32 v67, v67, v5
  v_lshlrev_b32 v4, 16, v58
  v_and_b32 v5, s40, v58
  v_add_f32 v68, v68, v4
  v_add_f32 v69, v69, v5
  v_lshlrev_b32 v4, 16, v59
  v_and_b32 v5, s40, v59
  v_add_f32 v70, v70, v4
  v_add_f32 v71, v71, v5
  s_waitcnt vmcnt(0)
  v_lshlrev_b32 v4, 16, v60
  v_and_b32 v5, s40, v60
  v_add_f32 v64, v64, v4
  v_add_f32 v65, v65, v5
  v_lshlrev_b32 v4, 16, v61
  v_and_b32 v5, s40, v61
  v_add_f32 v66, v66, v4
  v_add_f32 v67, v67, v5
  v_lshlrev_b32 v4, 16, v62
  v_and_b32 v5, s40, v62
  v_add_f32 v68, v68, v4
  v_add_f32 v69, v69, v5
  v_lshlrev_b32 v4, 16, v63
  v_and_b32 v5, s40, v63
  v_add_f32 v70, v70, v4
  v_add_f32 v71, v71, v5
  ds_write_b128 v3, v[64:67]
  ds_write_b128 v3, v[68:71] offset:1024
  s_waitcnt lgkmcnt(0)
  s_barrier
  s_cmp_lg_u32 s20, 0
  s_cbranch_scc1 K2_fin
  ds_read_b128 v[80:83], v11 offset:2048
  ds_read_b128 v[84:87], v11 offset:3072
  ds_read_b128 v[88:91], v11 offset:4096
  ds_read_b128 v[92:95], v11 offset:5120
  ds_read_b128 v[96:99], v11 offset:6144
  ds_read_b128 v[100:103], v11 offset:7168
  v_and_b32 v3, 31, v0
  v_lshlrev_b32 v3, 10, v3
  v_lshrrev_b32 v4, 5, v0
  v_lshlrev_b32 v4, 4, v4
  v_add_u32 v3, v3, v4
  s_lshl_b32 s32, s22, 15
  s_lshl_b32 s33, s47, 5
  s_add_u32 s32, s32, s33
  s_waitcnt lgkmcnt(0)
  v_add_f32 v64, v64, v80
  v_add_f32 v65, v65, v81
  v_add_f32 v66, v66, v82
  v_add_f32 v67, v67, v83
  v_add_f32 v68, v68, v84
  v_add_f32 v69, v69, v85
  v_add_f32 v70, v70, v86
  v_add_f32 v71, v71, v87
  v_add_f32 v64, v64, v88
  v_add_f32 v65, v65, v89
  v_add_f32 v66, v66, v90
  v_add_f32 v67, v67, v91
  v_add_f32 v68, v68, v92
  v_add_f32 v69, v69, v93
  v_add_f32 v70, v70, v94
  v_add_f32 v71, v71, v95
  v_add_f32 v64, v64, v96
  v_add_f32 v65, v65, v97
  v_add_f32 v66, v66, v98
  v_add_f32 v67, v67, v99
  v_add_f32 v68, v68, v100
  v_add_f32 v69, v69, v101
  v_add_f32 v70, v70, v102
  v_add_f32 v71, v71, v103
  v_cvt_pk_bf16_f32 v20, v64, v65
  v_cvt_pk_bf16_f32 v21, v66, v67
  v_cvt_pk_bf16_f32 v22, v68, v69
  v_cvt_pk_bf16_f32 v23, v70, v71
  s_nop 0
  v_permlane32_swap_b32 v20, v22
  v_permlane32_swap_b32 v21, v23
  buffer_store_dwordx4 v[20:23], v3, s[60:63], s32 offen
K2_fin:
K2_end:
  s_endpgm
RARE0:
  s_nop 15
  v_max3_f32 v28, v48, v49, v50
  v_max3_f32 v28, v28, v51, v52
  v_max3_f32 v28, v28, v53, v54
  v_max3_f32 v28, v28, v55, v56
  v_max3_f32 v28, v28, v57, v58
  v_max3_f32 v28, v28, v59, v60
  v_max3_f32 v28, v28, v61, v62
  v_max_f32 v28, v28, v63
  v_mov_b32 v29, v28
  s_nop 1
  v_permlane32_swap_b32 v28, v29
  v_max_f32 v28, v28, v29
  v_max_f32 v28, 0, v28
  v_add_f32 v24, v24, v28
  v_sub_f32 v29, 0, v28
  v_exp_f32 v29, v29
  v_sub_f32 v32, v32, v28
  v_sub_f32 v33, v33, v28
  v_sub_f32 v34, v34, v28
  v_sub_f32 v35, v35, v28
  v_sub_f32 v36, v36, v28
  v_sub_f32 v37, v37, v28
  v_sub_f32 v38, v38, v28
  v_sub_f32 v39, v39, v28
  v_sub_f32 v40, v40, v28
  v_sub_f32 v41, v41, v28
  v_sub_f32 v42, v42, v28
  v_sub_f32 v43, v43, v28
  v_sub_f32 v44, v44, v28
  v_sub_f32 v45, v45, v28
  v_sub_f32 v46, v46, v28
  v_sub_f32 v47, v47, v28
  v_sub_f32 v48, v48, v28
  v_sub_f32 v49, v49, v28
  v_sub_f32 v50, v50, v28
  v_sub_f32 v51, v51, v28
  v_sub_f32 v52, v52, v28
  v_sub_f32 v53, v53, v28
  v_sub_f32 v54, v54, v28
  v_sub_f32 v55, v55, v28
  v_sub_f32 v56, v56, v28
  v_sub_f32 v57, v57, v28
  v_sub_f32 v58, v58, v28
  v_sub_f32 v59, v59, v28
  v_sub_f32 v60, v60, v28
  v_sub_f32 v61, v61, v28
  v_sub_f32 v62, v62, v28
  v_sub_f32 v63, v63, v28
  v_sub_f32 v64, v64, v28
  v_sub_f32 v65, v65, v28
  v_sub_f32 v66, v66, v28
  v_sub_f32 v67, v67, v28
  v_sub_f32 v68, v68, v28
  v_sub_f32 v69, v69, v28
  v_sub_f32 v70, v70, v28
  v_sub_f32 v71, v71, v28
  v_sub_f32 v72, v72, v28
  v_sub_f32 v73, v73, v28
  v_sub_f32 v74, v74, v28
  v_sub_f32 v75, v75, v28
  v_sub_f32 v76, v76, v28
  v_sub_f32 v77, v77, v28
  v_sub_f32 v78, v78, v28
  v_sub_f32 v79, v79, v28
  v_mul_f32 v25, v25, v29
  v_mul_f32 v168, v168, v29
  v_mul_f32 v169, v169, v29
  v_mul_f32 v170, v170, v29
  v_mul_f32 v171, v171, v29
  v_mul_f32 v172, v172, v29
  v_mul_f32 v173, v173, v29
  v_mul_f32 v174, v174, v29
  v_mul_f32 v175, v175, v29
  v_mul_f32 v176, v176, v29
  v_mul_f32 v177, v177, v29
  v_mul_f32 v178, v178, v29
  v_mul_f32 v179, v179, v29
  v_mul_f32 v180, v180, v29
  v_mul_f32 v181, v181, v29
  v_mul_f32 v182, v182, v29
  v_mul_f32 v183, v183, v29
  v_mul_f32 v184, v184, v29
  v_mul_f32 v185, v185, v29
  v_mul_f32 v186, v186, v29
  v_mul_f32 v187, v187, v29
  v_mul_f32 v188, v188, v29
  v_mul_f32 v189, v189, v29
  v_mul_f32 v190, v190, v29
  v_mul_f32 v191, v191, v29
  v_mul_f32 v192, v192, v29
  v_mul_f32 v193, v193, v29
  v_mul_f32 v194, v194, v29
  v_mul_f32 v195, v195, v29
  v_mul_f32 v196, v196, v29
  v_mul_f32 v197, v197, v29
  v_mul_f32 v198, v198, v29
  v_mul_f32 v199, v199, v29
  v_mul_f32 v200, v200, v29
  v_mul_f32 v201, v201, v29
  v_mul_f32 v202, v202, v29
  v_mul_f32 v203, v203, v29
  v_mul_f32 v204, v204, v29
  v_mul_f32 v205, v205, v29
  v_mul_f32 v206, v206, v29
  v_mul_f32 v207, v207, v29
  v_mul_f32 v208, v208, v29
  v_mul_f32 v209, v209, v29
  v_mul_f32 v210, v210, v29
  v_mul_f32 v211, v211, v29
  v_mul_f32 v212, v212, v29
  v_mul_f32 v213, v213, v29
  v_mul_f32 v214, v214, v29
  v_mul_f32 v215, v215, v29
  v_mul_f32 v216, v216, v29
  v_mul_f32 v217, v217, v29
  v_mul_f32 v218, v218, v29
  v_mul_f32 v219, v219, v29
  v_mul_f32 v220, v220, v29
  v_mul_f32 v221, v221, v29
  v_mul_f32 v222, v222, v29
  v_mul_f32 v223, v223, v29
  v_mul_f32 v224, v224, v29
  v_mul_f32 v225, v225, v29
  v_mul_f32 v226, v226, v29
  v_mul_f32 v227, v227, v29
  v_mul_f32 v228, v228, v29
  v_mul_f32 v229, v229, v29
  v_mul_f32 v230, v230, v29
  v_mul_f32 v231, v231, v29
  v_exp_f32 v80, v48
  v_exp_f32 v81, v49
  s_nop 0
  v_exp_f32 v82, v50
  v_exp_f32 v83, v51
  v_cvt_pk_bf16_f32 v96, v80, v81
  s_nop 0
  v_exp_f32 v84, v52
  v_exp_f32 v85, v53
  v_add_f32 v26, v80, v82
  v_add_f32 v27, v81, v83
  v_cvt_pk_bf16_f32 v97, v82, v83
  s_nop 0
  v_exp_f32 v86, v54
  v_exp_f32 v87, v55
  v_add_f32 v26, v26, v84
  v_add_f32 v27, v27, v85
  v_cvt_pk_bf16_f32 v98, v84, v85
  s_nop 0
  v_exp_f32 v88, v56
  v_exp_f32 v89, v57
  v_add_f32 v26, v26, v86
  v_add_f32 v27, v27, v87
  v_cvt_pk_bf16_f32 v99, v86, v87
  s_nop 0
  v_exp_f32 v90, v58
  v_exp_f32 v91, v59
  v_add_f32 v26, v26, v88
  v_add_f32 v27, v27, v89
  v_cvt_pk_bf16_f32 v100, v88, v89
  s_nop 0
  v_exp_f32 v92, v60
  v_exp_f32 v93, v61
  v_add_f32 v26, v26, v90
  v_add_f32 v27, v27, v91
  v_cvt_pk_bf16_f32 v101, v90, v91
  s_nop 0
  v_exp_f32 v94, v62
  v_exp_f32 v95, v63
  v_add_f32 v26, v26, v92
  v_add_f32 v27, v27, v93
  v_cvt_pk_bf16_f32 v102, v92, v93
  s_nop 0
  v_add_f32 v26, v26, v94
  v_add_f32 v27, v27, v95
  v_cvt_pk_bf16_f32 v103, v94, v95
  s_nop 0
  v_add_f32 v26, v26, v27
  s_nop 1
  s_branch RET0
RARE1:
  s_nop 15
  v_max3_f32 v28, v64, v65, v66
  v_max3_f32 v28, v28, v67, v68
  v_max3_f32 v28, v28, v69, v70
  v_max3_f32 v28, v28, v71, v72
  v_max3_f32 v28, v28, v73, v74
  v_max3_f32 v28, v28, v75, v76
  v_max3_f32 v28, v28, v77, v78
  v_max_f32 v28, v28, v79
  v_mov_b32 v29, v28
  s_nop 1
  v_permlane32_swap_b32 v28, v29
  v_max_f32 v28, v28, v29
  v_max_f32 v28, 0, v28
  v_add_f32 v24, v24, v28
  v_sub_f32 v29, 0, v28
  v_exp_f32 v29, v29
  v_sub_f32 v32, v32, v28
  v_sub_f32 v33, v33, v28
  v_sub_f32 v34, v34, v28
  v_sub_f32 v35, v35, v28
  v_sub_f32 v36, v36, v28
  v_sub_f32 v37, v37, v28
  v_sub_f32 v38, v38, v28
  v_sub_f32 v39, v39, v28
  v_sub_f32 v40, v40, v28
  v_sub_f32 v41, v41, v28
  v_sub_f32 v42, v42, v28
  v_sub_f32 v43, v43, v28
  v_sub_f32 v44, v44, v28
  v_sub_f32 v45, v45, v28
  v_sub_f32 v46, v46, v28
  v_sub_f32 v47, v47, v28
  v_sub_f32 v64, v64, v28
  v_sub_f32 v65, v65, v28
  v_sub_f32 v66, v66, v28
  v_sub_f32 v67, v67, v28
  v_sub_f32 v68, v68, v28
  v_sub_f32 v69, v69, v28
  v_sub_f32 v70, v70, v28
  v_sub_f32 v71, v71, v28
  v_sub_f32 v72, v72, v28
  v_sub_f32 v73, v73, v28
  v_sub_f32 v74, v74, v28
  v_sub_f32 v75, v75, v28
  v_sub_f32 v76, v76, v28
  v_sub_f32 v77, v77, v28
  v_sub_f32 v78, v78, v28
  v_sub_f32 v79, v79, v28
  v_sub_f32 v48, v48, v28
  v_sub_f32 v49, v49, v28
  v_sub_f32 v50, v50, v28
  v_sub_f32 v51, v51, v28
  v_sub_f32 v52, v52, v28
  v_sub_f32 v53, v53, v28
  v_sub_f32 v54, v54, v28
  v_sub_f32 v55, v55, v28
  v_sub_f32 v56, v56, v28
  v_sub_f32 v57, v57, v28
  v_sub_f32 v58, v58, v28
  v_sub_f32 v59, v59, v28
  v_sub_f32 v60, v60, v28
  v_sub_f32 v61, v61, v28
  v_sub_f32 v62, v62, v28
  v_sub_f32 v63, v63, v28
  v_mul_f32 v25, v25, v29
  v_mul_f32 v168, v168, v29
  v_mul_f32 v169, v169, v29
  v_mul_f32 v170, v170, v29
  v_mul_f32 v171, v171, v29
  v_mul_f32 v172, v172, v29
  v_mul_f32 v173, v173, v29
  v_mul_f32 v174, v174, v29
  v_mul_f32 v175, v175, v29
  v_mul_f32 v176, v176, v29
  v_mul_f32 v177, v177, v29
  v_mul_f32 v178, v178, v29
  v_mul_f32 v179, v179, v29
  v_mul_f32 v180, v180, v29
  v_mul_f32 v181, v181, v29
  v_mul_f32 v182, v182, v29
  v_mul_f32 v183, v183, v29
  v_mul_f32 v184, v184, v29
  v_mul_f32 v185, v185, v29
  v_mul_f32 v186, v186, v29
  v_mul_f32 v187, v187, v29
  v_mul_f32 v188, v188, v29
  v_mul_f32 v189, v189, v29
  v_mul_f32 v190, v190, v29
  v_mul_f32 v191, v191, v29
  v_mul_f32 v192, v192, v29
  v_mul_f32 v193, v193, v29
  v_mul_f32 v194, v194, v29
  v_mul_f32 v195, v195, v29
  v_mul_f32 v196, v196, v29
  v_mul_f32 v197, v197, v29
  v_mul_f32 v198, v198, v29
  v_mul_f32 v199, v199, v29
  v_mul_f32 v200, v200, v29
  v_mul_f32 v201, v201, v29
  v_mul_f32 v202, v202, v29
  v_mul_f32 v203, v203, v29
  v_mul_f32 v204, v204, v29
  v_mul_f32 v205, v205, v29
  v_mul_f32 v206, v206, v29
  v_mul_f32 v207, v207, v29
  v_mul_f32 v208, v208, v29
  v_mul_f32 v209, v209, v29
  v_mul_f32 v210, v210, v29
  v_mul_f32 v211, v211, v29
  v_mul_f32 v212, v212, v29
  v_mul_f32 v213, v213, v29
  v_mul_f32 v214, v214, v29
  v_mul_f32 v215, v215, v29
  v_mul_f32 v216, v216, v29
  v_mul_f32 v217, v217, v29
  v_mul_f32 v218, v218, v29
  v_mul_f32 v219, v219, v29
  v_mul_f32 v220, v220, v29
  v_mul_f32 v221, v221, v29
  v_mul_f32 v222, v222, v29
  v_mul_f32 v223, v223, v29
  v_mul_f32 v224, v224, v29
  v_mul_f32 v225, v225, v29
  v_mul_f32 v226, v226, v29
  v_mul_f32 v227, v227, v29
  v_mul_f32 v228, v228, v29
  v_mul_f32 v229, v229, v29
  v_mul_f32 v230, v230, v29
  v_mul_f32 v231, v231, v29
  v_exp_f32 v80, v64
  v_exp_f32 v81, v65
  s_nop 0
  v_exp_f32 v82, v66
  v_exp_f32 v83, v67
  v_cvt_pk_bf16_f32 v96, v80, v81
  s_nop 0
  v_exp_f32 v84, v68
  v_exp_f32 v85, v69
  v_add_f32 v26, v80, v82
  v_add_f32 v27, v81, v83
  v_cvt_pk_bf16_f32 v97, v82, v83
  s_nop 0
  v_exp_f32 v86, v70
  v_exp_f32 v87, v71
  v_add_f32 v26, v26, v84
  v_add_f32 v27, v27, v85
  v_cvt_pk_bf16_f32 v98, v84, v85
  s_nop 0
  v_exp_f32 v88, v72
  v_exp_f32 v89, v73
  v_add_f32 v26, v26, v86
  v_add_f32 v27, v27, v87
  v_cvt_pk_bf16_f32 v99, v86, v87
  s_nop 0
  v_exp_f32 v90, v74
  v_exp_f32 v91, v75
  v_add_f32 v26, v26, v88
  v_add_f32 v27, v27, v89
  v_cvt_pk_bf16_f32 v100, v88, v89
  s_nop 0
  v_exp_f32 v92, v76
  v_exp_f32 v93, v77
  v_add_f32 v26, v26, v90
  v_add_f32 v27, v27, v91
  v_cvt_pk_bf16_f32 v101, v90, v91
  s_nop 0
  v_exp_f32 v94, v78
  v_exp_f32 v95, v79
  v_add_f32 v26, v26, v92
  v_add_f32 v27, v27, v93
  v_cvt_pk_bf16_f32 v102, v92, v93
  s_nop 0
  v_add_f32 v26, v26, v94
  v_add_f32 v27, v27, v95
  v_cvt_pk_bf16_f32 v103, v94, v95
  s_nop 0
  v_add_f32 v26, v26, v27
  s_nop 1
  s_branch RET1
RARE2:
  s_nop 15
  v_max3_f32 v28, v48, v49, v50
  v_max3_f32 v28, v28, v51, v52
  v_max3_f32 v28, v28, v53, v54
  v_max3_f32 v28, v28, v55, v56
  v_max3_f32 v28, v28, v57, v58
  v_max3_f32 v28, v28, v59, v60
  v_max3_f32 v28, v28, v61, v62
  v_max_f32 v28, v28, v63
  v_mov_b32 v29, v28
  s_nop 1
  v_permlane32_swap_b32 v28, v29
  v_max_f32 v28, v28, v29
  v_max_f32 v28, 0, v28
  v_add_f32 v24, v24, v28
  v_sub_f32 v29, 0, v28
  v_exp_f32 v29, v29
  v_sub_f32 v32, v32, v28
  v_sub_f32 v33, v33, v28
  v_sub_f32 v34, v34, v28
  v_sub_f32 v35, v35, v28
  v_sub_f32 v36, v36, v28
  v_sub_f32 v37, v37, v28
  v_sub_f32 v38, v38, v28
  v_sub_f32 v39, v39, v28
  v_sub_f32 v40, v40, v28
  v_sub_f32 v41, v41, v28
  v_sub_f32 v42, v42, v28
  v_sub_f32 v43, v43, v28
  v_sub_f32 v44, v44, v28
  v_sub_f32 v45, v45, v28
  v_sub_f32 v46, v46, v28
  v_sub_f32 v47, v47, v28
  v_sub_f32 v48, v48, v28
  v_sub_f32 v49, v49, v28
  v_sub_f32 v50, v50, v28
  v_sub_f32 v51, v51, v28
  v_sub_f32 v52, v52, v28
  v_sub_f32 v53, v53, v28
  v_sub_f32 v54, v54, v28
  v_sub_f32 v55, v55, v28
  v_sub_f32 v56, v56, v28
  v_sub_f32 v57, v57, v28
  v_sub_f32 v58, v58, v28
  v_sub_f32 v59, v59, v28
  v_sub_f32 v60, v60, v28
  v_sub_f32 v61, v61, v28
  v_sub_f32 v62, v62, v28
  v_sub_f32 v63, v63, v28
  v_sub_f32 v64, v64, v28
  v_sub_f32 v65, v65, v28
  v_sub_f32 v66, v66, v28
  v_sub_f32 v67, v67, v28
  v_sub_f32 v68, v68, v28
  v_sub_f32 v69, v69, v28
  v_sub_f32 v70, v70, v28
  v_sub_f32 v71, v71, v28
  v_sub_f32 v72, v72, v28
  v_sub_f32 v73, v73, v28
  v_sub_f32 v74, v74, v28
  v_sub_f32 v75, v75, v28
  v_sub_f32 v76, v76, v28
  v_sub_f32 v77, v77, v28
  v_sub_f32 v78, v78, v28
  v_sub_f32 v79, v79, v28
  v_mul_f32 v25, v25, v29
  v_mul_f32 v168, v168, v29
  v_mul_f32 v169, v169, v29
  v_mul_f32 v170, v170, v29
  v_mul_f32 v171, v171, v29
  v_mul_f32 v172, v172, v29
  v_mul_f32 v173, v173, v29
  v_mul_f32 v174, v174, v29
  v_mul_f32 v175, v175, v29
  v_mul_f32 v176, v176, v29
  v_mul_f32 v177, v177, v29
  v_mul_f32 v178, v178, v29
  v_mul_f32 v179, v179, v29
  v_mul_f32 v180, v180, v29
  v_mul_f32 v181, v181, v29
  v_mul_f32 v182, v182, v29
  v_mul_f32 v183, v183, v29
  v_mul_f32 v184, v184, v29
  v_mul_f32 v185, v185, v29
  v_mul_f32 v186, v186, v29
  v_mul_f32 v187, v187, v29
  v_mul_f32 v188, v188, v29
  v_mul_f32 v189, v189, v29
  v_mul_f32 v190, v190, v29
  v_mul_f32 v191, v191, v29
  v_mul_f32 v192, v192, v29
  v_mul_f32 v193, v193, v29
  v_mul_f32 v194, v194, v29
  v_mul_f32 v195, v195, v29
  v_mul_f32 v196, v196, v29
  v_mul_f32 v197, v197, v29
  v_mul_f32 v198, v198, v29
  v_mul_f32 v199, v199, v29
  v_mul_f32 v200, v200, v29
  v_mul_f32 v201, v201, v29
  v_mul_f32 v202, v202, v29
  v_mul_f32 v203, v203, v29
  v_mul_f32 v204, v204, v29
  v_mul_f32 v205, v205, v29
  v_mul_f32 v206, v206, v29
  v_mul_f32 v207, v207, v29
  v_mul_f32 v208, v208, v29
  v_mul_f32 v209, v209, v29
  v_mul_f32 v210, v210, v29
  v_mul_f32 v211, v211, v29
  v_mul_f32 v212, v212, v29
  v_mul_f32 v213, v213, v29
  v_mul_f32 v214, v214, v29
  v_mul_f32 v215, v215, v29
  v_mul_f32 v216, v216, v29
  v_mul_f32 v217, v217, v29
  v_mul_f32 v218, v218, v29
  v_mul_f32 v219, v219, v29
  v_mul_f32 v220, v220, v29
  v_mul_f32 v221, v221, v29
  v_mul_f32 v222, v222, v29
  v_mul_f32 v223, v223, v29
  v_mul_f32 v224, v224, v29
  v_mul_f32 v225, v225, v29
  v_mul_f32 v226, v226, v29
  v_mul_f32 v227, v227, v29
  v_mul_f32 v228, v228, v29
  v_mul_f32 v229, v229, v29
  v_mul_f32 v230, v230, v29
  v_mul_f32 v231, v231, v29
  v_exp_f32 v80, v48
  v_exp_f32 v81, v49
  s_nop 0
  v_exp_f32 v82, v50
  v_exp_f32 v83, v51
  v_cvt_pk_bf16_f32 v96, v80, v81
  s_nop 0
  v_exp_f32 v84, v52
  v_exp_f32 v85, v53
  v_add_f32 v26, v80, v82
  v_add_f32 v27, v81, v83
  v_cvt_pk_bf16_f32 v97, v82, v83
  s_nop 0
  v_exp_f32 v86, v54
  v_exp_f32 v87, v55
  v_add_f32 v26, v26, v84
  v_add_f32 v27, v27, v85
  v_cvt_pk_bf16_f32 v98, v84, v85
  s_nop 0
  v_exp_f32 v88, v56
  v_exp_f32 v89, v57
  v_add_f32 v26, v26, v86
  v_add_f32 v27, v27, v87
  v_cvt_pk_bf16_f32 v99, v86, v87
  s_nop 0
  v_exp_f32 v90, v58
  v_exp_f32 v91, v59
  v_add_f32 v26, v26, v88
  v_add_f32 v27, v27, v89
  v_cvt_pk_bf16_f32 v100, v88, v89
  s_nop 0
  v_exp_f32 v92, v60
  v_exp_f32 v93, v61
  v_add_f32 v26, v26, v90
  v_add_f32 v27, v27, v91
  v_cvt_pk_bf16_f32 v101, v90, v91
  s_nop 0
  v_exp_f32 v94, v62
  v_exp_f32 v95, v63
  v_add_f32 v26, v26, v92
  v_add_f32 v27, v27, v93
  v_cvt_pk_bf16_f32 v102, v92, v93
  s_nop 0
  v_add_f32 v26, v26, v94
  v_add_f32 v27, v27, v95
  v_cvt_pk_bf16_f32 v103, v94, v95
  s_nop 0
  v_add_f32 v26, v26, v27
  s_nop 1
  s_branch RET2
RARE3:
  s_nop 15
  v_max3_f32 v28, v64, v65, v66
  v_max3_f32 v28, v28, v67, v68
  v_max3_f32 v28, v28, v69, v70
  v_max3_f32 v28, v28, v71, v72
  v_max3_f32 v28, v28, v73, v74
  v_max3_f32 v28, v28, v75, v76
  v_max3_f32 v28, v28, v77, v78
  v_max_f32 v28, v28, v79
  v_mov_b32 v29, v28
  s_nop 1
  v_permlane32_swap_b32 v28, v29
  v_max_f32 v28, v28, v29
  v_max_f32 v28, 0, v28
  v_add_f32 v24, v24, v28
  v_sub_f32 v29, 0, v28
  v_exp_f32 v29, v29
  v_sub_f32 v32, v32, v28
  v_sub_f32 v33, v33, v28
  v_sub_f32 v34, v34, v28
  v_sub_f32 v35, v35, v28
  v_sub_f32 v36, v36, v28
  v_sub_f32 v37, v37, v28
  v_sub_f32 v38, v38, v28
  v_sub_f32 v39, v39, v28
  v_sub_f32 v40, v40, v28
  v_sub_f32 v41, v41, v28
  v_sub_f32 v42, v42, v28
  v_sub_f32 v43, v43, v28
  v_sub_f32 v44, v44, v28
  v_sub_f32 v45, v45, v28
  v_sub_f32 v46, v46, v28
  v_sub_f32 v47, v47, v28
  v_sub_f32 v64, v64, v28
  v_sub_f32 v65, v65, v28
  v_sub_f32 v66, v66, v28
  v_sub_f32 v67, v67, v28
  v_sub_f32 v68, v68, v28
  v_sub_f32 v69, v69, v28
  v_sub_f32 v70, v70, v28
  v_sub_f32 v71, v71, v28
  v_sub_f32 v72, v72, v28
  v_sub_f32 v73, v73, v28
  v_sub_f32 v74, v74, v28
  v_sub_f32 v75, v75, v28
  v_sub_f32 v76, v76, v28
  v_sub_f32 v77, v77, v28
  v_sub_f32 v78, v78, v28
  v_sub_f32 v79, v79, v28
  v_sub_f32 v48, v48, v28
  v_sub_f32 v49, v49, v28
  v_sub_f32 v50, v50, v28
  v_sub_f32 v51, v51, v28
  v_sub_f32 v52, v52, v28
  v_sub_f32 v53, v53, v28
  v_sub_f32 v54, v54, v28
  v_sub_f32 v55, v55, v28
  v_sub_f32 v56, v56, v28
  v_sub_f32 v57, v57, v28
  v_sub_f32 v58, v58, v28
  v_sub_f32 v59, v59, v28
  v_sub_f32 v60, v60, v28
  v_sub_f32 v61, v61, v28
  v_sub_f32 v62, v62, v28
  v_sub_f32 v63, v63, v28
  v_mul_f32 v25, v25, v29
  v_mul_f32 v168, v168, v29
  v_mul_f32 v169, v169, v29
  v_mul_f32 v170, v170, v29
  v_mul_f32 v171, v171, v29
  v_mul_f32 v172, v172, v29
  v_mul_f32 v173, v173, v29
  v_mul_f32 v174, v174, v29
  v_mul_f32 v175, v175, v29
  v_mul_f32 v176, v176, v29
  v_mul_f32 v177, v177, v29
  v_mul_f32 v178, v178, v29
  v_mul_f32 v179, v179, v29
  v_mul_f32 v180, v180, v29
  v_mul_f32 v181, v181, v29
  v_mul_f32 v182, v182, v29
  v_mul_f32 v183, v183, v29
  v_mul_f32 v184, v184, v29
  v_mul_f32 v185, v185, v29
  v_mul_f32 v186, v186, v29
  v_mul_f32 v187, v187, v29
  v_mul_f32 v188, v188, v29
  v_mul_f32 v189, v189, v29
  v_mul_f32 v190, v190, v29
  v_mul_f32 v191, v191, v29
  v_mul_f32 v192, v192, v29
  v_mul_f32 v193, v193, v29
  v_mul_f32 v194, v194, v29
  v_mul_f32 v195, v195, v29
  v_mul_f32 v196, v196, v29
  v_mul_f32 v197, v197, v29
  v_mul_f32 v198, v198, v29
  v_mul_f32 v199, v199, v29
  v_mul_f32 v200, v200, v29
  v_mul_f32 v201, v201, v29
  v_mul_f32 v202, v202, v29
  v_mul_f32 v203, v203, v29
  v_mul_f32 v204, v204, v29
  v_mul_f32 v205, v205, v29
  v_mul_f32 v206, v206, v29
  v_mul_f32 v207, v207, v29
  v_mul_f32 v208, v208, v29
  v_mul_f32 v209, v209, v29
  v_mul_f32 v210, v210, v29
  v_mul_f32 v211, v211, v29
  v_mul_f32 v212, v212, v29
  v_mul_f32 v213, v213, v29
  v_mul_f32 v214, v214, v29
  v_mul_f32 v215, v215, v29
  v_mul_f32 v216, v216, v29
  v_mul_f32 v217, v217, v29
  v_mul_f32 v218, v218, v29
  v_mul_f32 v219, v219, v29
  v_mul_f32 v220, v220, v29
  v_mul_f32 v221, v221, v29
  v_mul_f32 v222, v222, v29
  v_mul_f32 v223, v223, v29
  v_mul_f32 v224, v224, v29
  v_mul_f32 v225, v225, v29
  v_mul_f32 v226, v226, v29
  v_mul_f32 v227, v227, v29
  v_mul_f32 v228, v228, v29
  v_mul_f32 v229, v229, v29
  v_mul_f32 v230, v230, v29
  v_mul_f32 v231, v231, v29
  v_exp_f32 v80, v64
  v_exp_f32 v81, v65
  s_nop 0
  v_exp_f32 v82, v66
  v_exp_f32 v83, v67
  v_cvt_pk_bf16_f32 v96, v80, v81
  s_nop 0
  v_exp_f32 v84, v68
  v_exp_f32 v85, v69
  v_add_f32 v26, v80, v82
  v_add_f32 v27, v81, v83
  v_cvt_pk_bf16_f32 v97, v82, v83
  s_nop 0
  v_exp_f32 v86, v70
  v_exp_f32 v87, v71
  v_add_f32 v26, v26, v84
  v_add_f32 v27, v27, v85
  v_cvt_pk_bf16_f32 v98, v84, v85
  s_nop 0
  v_exp_f32 v88, v72
  v_exp_f32 v89, v73
  v_add_f32 v26, v26, v86
  v_add_f32 v27, v27, v87
  v_cvt_pk_bf16_f32 v99, v86, v87
  s_nop 0
  v_exp_f32 v90, v74
  v_exp_f32 v91, v75
  v_add_f32 v26, v26, v88
  v_add_f32 v27, v27, v89
  v_cvt_pk_bf16_f32 v100, v88, v89
  s_nop 0
  v_exp_f32 v92, v76
  v_exp_f32 v93, v77
  v_add_f32 v26, v26, v90
  v_add_f32 v27, v27, v91
  v_cvt_pk_bf16_f32 v101, v90, v91
  s_nop 0
  v_exp_f32 v94, v78
  v_exp_f32 v95, v79
  v_add_f32 v26, v26, v92
  v_add_f32 v27, v27, v93
  v_cvt_pk_bf16_f32 v102, v92, v93
  s_nop 0
  v_add_f32 v26, v26, v94
  v_add_f32 v27, v27, v95
  v_cvt_pk_bf16_f32 v103, v94, v95
  s_nop 0
  v_add_f32 v26, v26, v27
  s_nop 1
  s_branch RET3
RARE4:
  s_nop 15
  v_max3_f32 v28, v48, v49, v50
  v_max3_f32 v28, v28, v51, v52
  v_max3_f32 v28, v28, v53, v54
  v_max3_f32 v28, v28, v55, v56
  v_max3_f32 v28, v28, v57, v58
  v_max3_f32 v28, v28, v59, v60
  v_max3_f32 v28, v28, v61, v62
  v_max_f32 v28, v28, v63
  v_mov_b32 v29, v28
  s_nop 1
  v_permlane32_swap_b32 v28, v29
  v_max_f32 v28, v28, v29
  v_max_f32 v28, 0, v28
  v_add_f32 v24, v24, v28
  v_sub_f32 v29, 0, v28
  v_exp_f32 v29, v29
  v_sub_f32 v32, v32, v28
  v_sub_f32 v33, v33, v28
  v_sub_f32 v34, v34, v28
  v_sub_f32 v35, v35, v28
  v_sub_f32 v36, v36, v28
  v_sub_f32 v37, v37, v28
  v_sub_f32 v38, v38, v28
  v_sub_f32 v39, v39, v28
  v_sub_f32 v40, v40, v28
  v_sub_f32 v41, v41, v28
  v_sub_f32 v42, v42, v28
  v_sub_f32 v43, v43, v28
  v_sub_f32 v44, v44, v28
  v_sub_f32 v45, v45, v28
  v_sub_f32 v46, v46, v28
  v_sub_f32 v47, v47, v28
  v_sub_f32 v48, v48, v28
  v_sub_f32 v49, v49, v28
  v_sub_f32 v50, v50, v28
  v_sub_f32 v51, v51, v28
  v_sub_f32 v52, v52, v28
  v_sub_f32 v53, v53, v28
  v_sub_f32 v54, v54, v28
  v_sub_f32 v55, v55, v28
  v_sub_f32 v56, v56, v28
  v_sub_f32 v57, v57, v28
  v_sub_f32 v58, v58, v28
  v_sub_f32 v59, v59, v28
  v_sub_f32 v60, v60, v28
  v_sub_f32 v61, v61, v28
  v_sub_f32 v62, v62, v28
  v_sub_f32 v63, v63, v28
  v_sub_f32 v64, v64, v28
  v_sub_f32 v65, v65, v28
  v_sub_f32 v66, v66, v28
  v_sub_f32 v67, v67, v28
  v_sub_f32 v68, v68, v28
  v_sub_f32 v69, v69, v28
  v_sub_f32 v70, v70, v28
  v_sub_f32 v71, v71, v28
  v_sub_f32 v72, v72, v28
  v_sub_f32 v73, v73, v28
  v_sub_f32 v74, v74, v28
  v_sub_f32 v75, v75, v28
  v_sub_f32 v76, v76, v28
  v_sub_f32 v77, v77, v28
  v_sub_f32 v78, v78, v28
  v_sub_f32 v79, v79, v28
  v_mul_f32 v25, v25, v29
  v_mul_f32 v168, v168, v29
  v_mul_f32 v169, v169, v29
  v_mul_f32 v170, v170, v29
  v_mul_f32 v171, v171, v29
  v_mul_f32 v172, v172, v29
  v_mul_f32 v173, v173, v29
  v_mul_f32 v174, v174, v29
  v_mul_f32 v175, v175, v29
  v_mul_f32 v176, v176, v29
  v_mul_f32 v177, v177, v29
  v_mul_f32 v178, v178, v29
  v_mul_f32 v179, v179, v29
  v_mul_f32 v180, v180, v29
  v_mul_f32 v181, v181, v29
  v_mul_f32 v182, v182, v29
  v_mul_f32 v183, v183, v29
  v_mul_f32 v184, v184, v29
  v_mul_f32 v185, v185, v29
  v_mul_f32 v186, v186, v29
  v_mul_f32 v187, v187, v29
  v_mul_f32 v188, v188, v29
  v_mul_f32 v189, v189, v29
  v_mul_f32 v190, v190, v29
  v_mul_f32 v191, v191, v29
  v_mul_f32 v192, v192, v29
  v_mul_f32 v193, v193, v29
  v_mul_f32 v194, v194, v29
  v_mul_f32 v195, v195, v29
  v_mul_f32 v196, v196, v29
  v_mul_f32 v197, v197, v29
  v_mul_f32 v198, v198, v29
  v_mul_f32 v199, v199, v29
  v_mul_f32 v200, v200, v29
  v_mul_f32 v201, v201, v29
  v_mul_f32 v202, v202, v29
  v_mul_f32 v203, v203, v29
  v_mul_f32 v204, v204, v29
  v_mul_f32 v205, v205, v29
  v_mul_f32 v206, v206, v29
  v_mul_f32 v207, v207, v29
  v_mul_f32 v208, v208, v29
  v_mul_f32 v209, v209, v29
  v_mul_f32 v210, v210, v29
  v_mul_f32 v211, v211, v29
  v_mul_f32 v212, v212, v29
  v_mul_f32 v213, v213, v29
  v_mul_f32 v214, v214, v29
  v_mul_f32 v215, v215, v29
  v_mul_f32 v216, v216, v29
  v_mul_f32 v217, v217, v29
  v_mul_f32 v218, v218, v29
  v_mul_f32 v219, v219, v29
  v_mul_f32 v220, v220, v29
  v_mul_f32 v221, v221, v29
  v_mul_f32 v222, v222, v29
  v_mul_f32 v223, v223, v29
  v_mul_f32 v224, v224, v29
  v_mul_f32 v225, v225, v29
  v_mul_f32 v226, v226, v29
  v_mul_f32 v227, v227, v29
  v_mul_f32 v228, v228, v29
  v_mul_f32 v229, v229, v29
  v_mul_f32 v230, v230, v29
  v_mul_f32 v231, v231, v29
  v_exp_f32 v80, v48
  v_exp_f32 v81, v49
  s_nop 0
  v_exp_f32 v82, v50
  v_exp_f32 v83, v51
  v_cvt_pk_bf16_f32 v96, v80, v81
  s_nop 0
  v_exp_f32 v84, v52
  v_exp_f32 v85, v53
  v_add_f32 v26, v80, v82
  v_add_f32 v27, v81, v83
  v_cvt_pk_bf16_f32 v97, v82, v83
  s_nop 0
  v_exp_f32 v86, v54
  v_exp_f32 v87, v55
  v_add_f32 v26, v26, v84
  v_add_f32 v27, v27, v85
  v_cvt_pk_bf16_f32 v98, v84, v85
  s_nop 0
  v_exp_f32 v88, v56
  v_exp_f32 v89, v57
  v_add_f32 v26, v26, v86
  v_add_f32 v27, v27, v87
  v_cvt_pk_bf16_f32 v99, v86, v87
  s_nop 0
  v_exp_f32 v90, v58
  v_exp_f32 v91, v59
  v_add_f32 v26, v26, v88
  v_add_f32 v27, v27, v89
  v_cvt_pk_bf16_f32 v100, v88, v89
  s_nop 0
  v_exp_f32 v92, v60
  v_exp_f32 v93, v61
  v_add_f32 v26, v26, v90
  v_add_f32 v27, v27, v91
  v_cvt_pk_bf16_f32 v101, v90, v91
  s_nop 0
  v_exp_f32 v94, v62
  v_exp_f32 v95, v63
  v_add_f32 v26, v26, v92
  v_add_f32 v27, v27, v93
  v_cvt_pk_bf16_f32 v102, v92, v93
  s_nop 0
  v_add_f32 v26, v26, v94
  v_add_f32 v27, v27, v95
  v_cvt_pk_bf16_f32 v103, v94, v95
  s_nop 0
  v_add_f32 v26, v26, v27
  s_nop 1
  s_branch RET4
RARE5:
  s_nop 15
  v_max3_f32 v28, v64, v65, v66
  v_max3_f32 v28, v28, v67, v68
  v_max3_f32 v28, v28, v69, v70
  v_max3_f32 v28, v28, v71, v72
  v_max3_f32 v28, v28, v73, v74
  v_max3_f32 v28, v28, v75, v76
  v_max3_f32 v28, v28, v77, v78
  v_max_f32 v28, v28, v79
  v_mov_b32 v29, v28
  s_nop 1
  v_permlane32_swap_b32 v28, v29
  v_max_f32 v28, v28, v29
  v_max_f32 v28, 0, v28
  v_add_f32 v24, v24, v28
  v_sub_f32 v29, 0, v28
  v_exp_f32 v29, v29
  v_sub_f32 v32, v32, v28
  v_sub_f32 v33, v33, v28
  v_sub_f32 v34, v34, v28
  v_sub_f32 v35, v35, v28
  v_sub_f32 v36, v36, v28
  v_sub_f32 v37, v37, v28
  v_sub_f32 v38, v38, v28
  v_sub_f32 v39, v39, v28
  v_sub_f32 v40, v40, v28
  v_sub_f32 v41, v41, v28
  v_sub_f32 v42, v42, v28
  v_sub_f32 v43, v43, v28
  v_sub_f32 v44, v44, v28
  v_sub_f32 v45, v45, v28
  v_sub_f32 v46, v46, v28
  v_sub_f32 v47, v47, v28
  v_sub_f32 v64, v64, v28
  v_sub_f32 v65, v65, v28
  v_sub_f32 v66, v66, v28
  v_sub_f32 v67, v67, v28
  v_sub_f32 v68, v68, v28
  v_sub_f32 v69, v69, v28
  v_sub_f32 v70, v70, v28
  v_sub_f32 v71, v71, v28
  v_sub_f32 v72, v72, v28
  v_sub_f32 v73, v73, v28
  v_sub_f32 v74, v74, v28
  v_sub_f32 v75, v75, v28
  v_sub_f32 v76, v76, v28
  v_sub_f32 v77, v77, v28
  v_sub_f32 v78, v78, v28
  v_sub_f32 v79, v79, v28
  v_sub_f32 v48, v48, v28
  v_sub_f32 v49, v49, v28
  v_sub_f32 v50, v50, v28
  v_sub_f32 v51, v51, v28
  v_sub_f32 v52, v52, v28
  v_sub_f32 v53, v53, v28
  v_sub_f32 v54, v54, v28
  v_sub_f32 v55, v55, v28
  v_sub_f32 v56, v56, v28
  v_sub_f32 v57, v57, v28
  v_sub_f32 v58, v58, v28
  v_sub_f32 v59, v59, v28
  v_sub_f32 v60, v60, v28
  v_sub_f32 v61, v61, v28
  v_sub_f32 v62, v62, v28
  v_sub_f32 v63, v63, v28
  v_mul_f32 v25, v25, v29
  v_mul_f32 v168, v168, v29
  v_mul_f32 v169, v169, v29
  v_mul_f32 v170, v170, v29
  v_mul_f32 v171, v171, v29
  v_mul_f32 v172, v172, v29
  v_mul_f32 v173, v173, v29
  v_mul_f32 v174, v174, v29
  v_mul_f32 v175, v175, v29
  v_mul_f32 v176, v176, v29
  v_mul_f32 v177, v177, v29
  v_mul_f32 v178, v178, v29
  v_mul_f32 v179, v179, v29
  v_mul_f32 v180, v180, v29
  v_mul_f32 v181, v181, v29
  v_mul_f32 v182, v182, v29
  v_mul_f32 v183, v183, v29
  v_mul_f32 v184, v184, v29
  v_mul_f32 v185, v185, v29
  v_mul_f32 v186, v186, v29
  v_mul_f32 v187, v187, v29
  v_mul_f32 v188, v188, v29
  v_mul_f32 v189, v189, v29
  v_mul_f32 v190, v190, v29
  v_mul_f32 v191, v191, v29
  v_mul_f32 v192, v192, v29
  v_mul_f32 v193, v193, v29
  v_mul_f32 v194, v194, v29
  v_mul_f32 v195, v195, v29
  v_mul_f32 v196, v196, v29
  v_mul_f32 v197, v197, v29
  v_mul_f32 v198, v198, v29
  v_mul_f32 v199, v199, v29
  v_mul_f32 v200, v200, v29
  v_mul_f32 v201, v201, v29
  v_mul_f32 v202, v202, v29
  v_mul_f32 v203, v203, v29
  v_mul_f32 v204, v204, v29
  v_mul_f32 v205, v205, v29
  v_mul_f32 v206, v206, v29
  v_mul_f32 v207, v207, v29
  v_mul_f32 v208, v208, v29
  v_mul_f32 v209, v209, v29
  v_mul_f32 v210, v210, v29
  v_mul_f32 v211, v211, v29
  v_mul_f32 v212, v212, v29
  v_mul_f32 v213, v213, v29
  v_mul_f32 v214, v214, v29
  v_mul_f32 v215, v215, v29
  v_mul_f32 v216, v216, v29
  v_mul_f32 v217, v217, v29
  v_mul_f32 v218, v218, v29
  v_mul_f32 v219, v219, v29
  v_mul_f32 v220, v220, v29
  v_mul_f32 v221, v221, v29
  v_mul_f32 v222, v222, v29
  v_mul_f32 v223, v223, v29
  v_mul_f32 v224, v224, v29
  v_mul_f32 v225, v225, v29
  v_mul_f32 v226, v226, v29
  v_mul_f32 v227, v227, v29
  v_mul_f32 v228, v228, v29
  v_mul_f32 v229, v229, v29
  v_mul_f32 v230, v230, v29
  v_mul_f32 v231, v231, v29
  v_exp_f32 v80, v64
  v_exp_f32 v81, v65
  s_nop 0
  v_exp_f32 v82, v66
  v_exp_f32 v83, v67
  v_cvt_pk_bf16_f32 v96, v80, v81
  s_nop 0
  v_exp_f32 v84, v68
  v_exp_f32 v85, v69
  v_add_f32 v26, v80, v82
  v_add_f32 v27, v81, v83
  v_cvt_pk_bf16_f32 v97, v82, v83
  s_nop 0
  v_exp_f32 v86, v70
  v_exp_f32 v87, v71
  v_add_f32 v26, v26, v84
  v_add_f32 v27, v27, v85
  v_cvt_pk_bf16_f32 v98, v84, v85
  s_nop 0
  v_exp_f32 v88, v72
  v_exp_f32 v89, v73
  v_add_f32 v26, v26, v86
  v_add_f32 v27, v27, v87
  v_cvt_pk_bf16_f32 v99, v86, v87
  s_nop 0
  v_exp_f32 v90, v74
  v_exp_f32 v91, v75
  v_add_f32 v26, v26, v88
  v_add_f32 v27, v27, v89
  v_cvt_pk_bf16_f32 v100, v88, v89
  s_nop 0
  v_exp_f32 v92, v76
  v_exp_f32 v93, v77
  v_add_f32 v26, v26, v90
  v_add_f32 v27, v27, v91
  v_cvt_pk_bf16_f32 v101, v90, v91
  s_nop 0
  v_exp_f32 v94, v78
  v_exp_f32 v95, v79
  v_add_f32 v26, v26, v92
  v_add_f32 v27, v27, v93
  v_cvt_pk_bf16_f32 v102, v92, v93
  s_nop 0
  v_add_f32 v26, v26, v94
  v_add_f32 v27, v27, v95
  v_cvt_pk_bf16_f32 v103, v94, v95
  s_nop 0
  v_add_f32 v26, v26, v27
  s_nop 1
  s_branch RET5
RARE6:
  s_nop 15
  v_max3_f32 v28, v48, v49, v50
  v_max3_f32 v28, v28, v51, v52
  v_max3_f32 v28, v28, v53, v54
  v_max3_f32 v28, v28, v55, v56
  v_max3_f32 v28, v28, v57, v58
  v_max3_f32 v28, v28, v59, v60
  v_max3_f32 v28, v28, v61, v62
  v_max_f32 v28, v28, v63
  v_mov_b32 v29, v28
  s_nop 1
  v_permlane32_swap_b32 v28, v29
  v_max_f32 v28, v28, v29
  v_max_f32 v28, 0, v28
  v_add_f32 v24, v24, v28
  v_sub_f32 v29, 0, v28
  v_exp_f32 v29, v29
  v_sub_f32 v32, v32, v28
  v_sub_f32 v33, v33, v28
  v_sub_f32 v34, v34, v28
  v_sub_f32 v35, v35, v28
  v_sub_f32 v36, v36, v28
  v_sub_f32 v37, v37, v28
  v_sub_f32 v38, v38, v28
  v_sub_f32 v39, v39, v28
  v_sub_f32 v40, v40, v28
  v_sub_f32 v41, v41, v28
  v_sub_f32 v42, v42, v28
  v_sub_f32 v43, v43, v28
  v_sub_f32 v44, v44, v28
  v_sub_f32 v45, v45, v28
  v_sub_f32 v46, v46, v28
  v_sub_f32 v47, v47, v28
  v_sub_f32 v48, v48, v28
  v_sub_f32 v49, v49, v28
  v_sub_f32 v50, v50, v28
  v_sub_f32 v51, v51, v28
  v_sub_f32 v52, v52, v28
  v_sub_f32 v53, v53, v28
  v_sub_f32 v54, v54, v28
  v_sub_f32 v55, v55, v28
  v_sub_f32 v56, v56, v28
  v_sub_f32 v57, v57, v28
  v_sub_f32 v58, v58, v28
  v_sub_f32 v59, v59, v28
  v_sub_f32 v60, v60, v28
  v_sub_f32 v61, v61, v28
  v_sub_f32 v62, v62, v28
  v_sub_f32 v63, v63, v28
  v_sub_f32 v64, v64, v28
  v_sub_f32 v65, v65, v28
  v_sub_f32 v66, v66, v28
  v_sub_f32 v67, v67, v28
  v_sub_f32 v68, v68, v28
  v_sub_f32 v69, v69, v28
  v_sub_f32 v70, v70, v28
  v_sub_f32 v71, v71, v28
  v_sub_f32 v72, v72, v28
  v_sub_f32 v73, v73, v28
  v_sub_f32 v74, v74, v28
  v_sub_f32 v75, v75, v28
  v_sub_f32 v76, v76, v28
  v_sub_f32 v77, v77, v28
  v_sub_f32 v78, v78, v28
  v_sub_f32 v79, v79, v28
  v_mul_f32 v25, v25, v29
  v_mul_f32 v168, v168, v29
  v_mul_f32 v169, v169, v29
  v_mul_f32 v170, v170, v29
  v_mul_f32 v171, v171, v29
  v_mul_f32 v172, v172, v29
  v_mul_f32 v173, v173, v29
  v_mul_f32 v174, v174, v29
  v_mul_f32 v175, v175, v29
  v_mul_f32 v176, v176, v29
  v_mul_f32 v177, v177, v29
  v_mul_f32 v178, v178, v29
  v_mul_f32 v179, v179, v29
  v_mul_f32 v180, v180, v29
  v_mul_f32 v181, v181, v29
  v_mul_f32 v182, v182, v29
  v_mul_f32 v183, v183, v29
  v_mul_f32 v184, v184, v29
  v_mul_f32 v185, v185, v29
  v_mul_f32 v186, v186, v29
  v_mul_f32 v187, v187, v29
  v_mul_f32 v188, v188, v29
  v_mul_f32 v189, v189, v29
  v_mul_f32 v190, v190, v29
  v_mul_f32 v191, v191, v29
  v_mul_f32 v192, v192, v29
  v_mul_f32 v193, v193, v29
  v_mul_f32 v194, v194, v29
  v_mul_f32 v195, v195, v29
  v_mul_f32 v196, v196, v29
  v_mul_f32 v197, v197, v29
  v_mul_f32 v198, v198, v29
  v_mul_f32 v199, v199, v29
  v_mul_f32 v200, v200, v29
  v_mul_f32 v201, v201, v29
  v_mul_f32 v202, v202, v29
  v_mul_f32 v203, v203, v29
  v_mul_f32 v204, v204, v29
  v_mul_f32 v205, v205, v29
  v_mul_f32 v206, v206, v29
  v_mul_f32 v207, v207, v29
  v_mul_f32 v208, v208, v29
  v_mul_f32 v209, v209, v29
  v_mul_f32 v210, v210, v29
  v_mul_f32 v211, v211, v29
  v_mul_f32 v212, v212, v29
  v_mul_f32 v213, v213, v29
  v_mul_f32 v214, v214, v29
  v_mul_f32 v215, v215, v29
  v_mul_f32 v216, v216, v29
  v_mul_f32 v217, v217, v29
  v_mul_f32 v218, v218, v29
  v_mul_f32 v219, v219, v29
  v_mul_f32 v220, v220, v29
  v_mul_f32 v221, v221, v29
  v_mul_f32 v222, v222, v29
  v_mul_f32 v223, v223, v29
  v_mul_f32 v224, v224, v29
  v_mul_f32 v225, v225, v29
  v_mul_f32 v226, v226, v29
  v_mul_f32 v227, v227, v29
  v_mul_f32 v228, v228, v29
  v_mul_f32 v229, v229, v29
  v_mul_f32 v230, v230, v29
  v_mul_f32 v231, v231, v29
  v_exp_f32 v80, v48
  v_exp_f32 v81, v49
  s_nop 0
  v_exp_f32 v82, v50
  v_exp_f32 v83, v51
  v_cvt_pk_bf16_f32 v96, v80, v81
  s_nop 0
  v_exp_f32 v84, v52
  v_exp_f32 v85, v53
  v_add_f32 v26, v80, v82
  v_add_f32 v27, v81, v83
  v_cvt_pk_bf16_f32 v97, v82, v83
  s_nop 0
  v_exp_f32 v86, v54
  v_exp_f32 v87, v55
  v_add_f32 v26, v26, v84
  v_add_f32 v27, v27, v85
  v_cvt_pk_bf16_f32 v98, v84, v85
  s_nop 0
  v_exp_f32 v88, v56
  v_exp_f32 v89, v57
  v_add_f32 v26, v26, v86
  v_add_f32 v27, v27, v87
  v_cvt_pk_bf16_f32 v99, v86, v87
  s_nop 0
  v_exp_f32 v90, v58
  v_exp_f32 v91, v59
  v_add_f32 v26, v26, v88
  v_add_f32 v27, v27, v89
  v_cvt_pk_bf16_f32 v100, v88, v89
  s_nop 0
  v_exp_f32 v92, v60
  v_exp_f32 v93, v61
  v_add_f32 v26, v26, v90
  v_add_f32 v27, v27, v91
  v_cvt_pk_bf16_f32 v101, v90, v91
  s_nop 0
  v_exp_f32 v94, v62
  v_exp_f32 v95, v63
  v_add_f32 v26, v26, v92
  v_add_f32 v27, v27, v93
  v_cvt_pk_bf16_f32 v102, v92, v93
  s_nop 0
  v_add_f32 v26, v26, v94
  v_add_f32 v27, v27, v95
  v_cvt_pk_bf16_f32 v103, v94, v95
  s_nop 0
  v_add_f32 v26, v26, v27
  s_nop 1
  s_branch RET6
RARE7:
  s_nop 15
  v_max3_f32 v28, v64, v65, v66
  v_max3_f32 v28, v28, v67, v68
  v_max3_f32 v28, v28, v69, v70
  v_max3_f32 v28, v28, v71, v72
  v_max3_f32 v28, v28, v73, v74
  v_max3_f32 v28, v28, v75, v76
  v_max3_f32 v28, v28, v77, v78
  v_max_f32 v28, v28, v79
  v_mov_b32 v29, v28
  s_nop 1
  v_permlane32_swap_b32 v28, v29
  v_max_f32 v28, v28, v29
  v_max_f32 v28, 0, v28
  v_add_f32 v24, v24, v28
  v_sub_f32 v29, 0, v28
  v_exp_f32 v29, v29
  v_sub_f32 v32, v32, v28
  v_sub_f32 v33, v33, v28
  v_sub_f32 v34, v34, v28
  v_sub_f32 v35, v35, v28
  v_sub_f32 v36, v36, v28
  v_sub_f32 v37, v37, v28
  v_sub_f32 v38, v38, v28
  v_sub_f32 v39, v39, v28
  v_sub_f32 v40, v40, v28
  v_sub_f32 v41, v41, v28
  v_sub_f32 v42, v42, v28
  v_sub_f32 v43, v43, v28
  v_sub_f32 v44, v44, v28
  v_sub_f32 v45, v45, v28
  v_sub_f32 v46, v46, v28
  v_sub_f32 v47, v47, v28
  v_sub_f32 v64, v64, v28
  v_sub_f32 v65, v65, v28
  v_sub_f32 v66, v66, v28
  v_sub_f32 v67, v67, v28
  v_sub_f32 v68, v68, v28
  v_sub_f32 v69, v69, v28
  v_sub_f32 v70, v70, v28
  v_sub_f32 v71, v71, v28
  v_sub_f32 v72, v72, v28
  v_sub_f32 v73, v73, v28
  v_sub_f32 v74, v74, v28
  v_sub_f32 v75, v75, v28
  v_sub_f32 v76, v76, v28
  v_sub_f32 v77, v77, v28
  v_sub_f32 v78, v78, v28
  v_sub_f32 v79, v79, v28
  v_mul_f32 v25, v25, v29
  v_mul_f32 v168, v168, v29
  v_mul_f32 v169, v169, v29
  v_mul_f32 v170, v170, v29
  v_mul_f32 v171, v171, v29
  v_mul_f32 v172, v172, v29
  v_mul_f32 v173, v173, v29
  v_mul_f32 v174, v174, v29
  v_mul_f32 v175, v175, v29
  v_mul_f32 v176, v176, v29
  v_mul_f32 v177, v177, v29
  v_mul_f32 v178, v178, v29
  v_mul_f32 v179, v179, v29
  v_mul_f32 v180, v180, v29
  v_mul_f32 v181, v181, v29
  v_mul_f32 v182, v182, v29
  v_mul_f32 v183, v183, v29
  v_mul_f32 v184, v184, v29
  v_mul_f32 v185, v185, v29
  v_mul_f32 v186, v186, v29
  v_mul_f32 v187, v187, v29
  v_mul_f32 v188, v188, v29
  v_mul_f32 v189, v189, v29
  v_mul_f32 v190, v190, v29
  v_mul_f32 v191, v191, v29
  v_mul_f32 v192, v192, v29
  v_mul_f32 v193, v193, v29
  v_mul_f32 v194, v194, v29
  v_mul_f32 v195, v195, v29
  v_mul_f32 v196, v196, v29
  v_mul_f32 v197, v197, v29
  v_mul_f32 v198, v198, v29
  v_mul_f32 v199, v199, v29
  v_mul_f32 v200, v200, v29
  v_mul_f32 v201, v201, v29
  v_mul_f32 v202, v202, v29
  v_mul_f32 v203, v203, v29
  v_mul_f32 v204, v204, v29
  v_mul_f32 v205, v205, v29
  v_mul_f32 v206, v206, v29
  v_mul_f32 v207, v207, v29
  v_mul_f32 v208, v208, v29
  v_mul_f32 v209, v209, v29
  v_mul_f32 v210, v210, v29
  v_mul_f32 v211, v211, v29
  v_mul_f32 v212, v212, v29
  v_mul_f32 v213, v213, v29
  v_mul_f32 v214, v214, v29
  v_mul_f32 v215, v215, v29
  v_mul_f32 v216, v216, v29
  v_mul_f32 v217, v217, v29
  v_mul_f32 v218, v218, v29
  v_mul_f32 v219, v219, v29
  v_mul_f32 v220, v220, v29
  v_mul_f32 v221, v221, v29
  v_mul_f32 v222, v222, v29
  v_mul_f32 v223, v223, v29
  v_mul_f32 v224, v224, v29
  v_mul_f32 v225, v225, v29
  v_mul_f32 v226, v226, v29
  v_mul_f32 v227, v227, v29
  v_mul_f32 v228, v228, v29
  v_mul_f32 v229, v229, v29
  v_mul_f32 v230, v230, v29
  v_mul_f32 v231, v231, v29
  v_exp_f32 v80, v64
  v_exp_f32 v81, v65
  s_nop 0
  v_exp_f32 v82, v66
  v_exp_f32 v83, v67
  v_cvt_pk_bf16_f32 v96, v80, v81
  s_nop 0
  v_exp_f32 v84, v68
  v_exp_f32 v85, v69
  v_add_f32 v26, v80, v82
  v_add_f32 v27, v81, v83
  v_cvt_pk_bf16_f32 v97, v82, v83
  s_nop 0
  v_exp_f32 v86, v70
  v_exp_f32 v87, v71
  v_add_f32 v26, v26, v84
  v_add_f32 v27, v27, v85
  v_cvt_pk_bf16_f32 v98, v84, v85
  s_nop 0
  v_exp_f32 v88, v72
  v_exp_f32 v89, v73
  v_add_f32 v26, v26, v86
  v_add_f32 v27, v27, v87
  v_cvt_pk_bf16_f32 v99, v86, v87
  s_nop 0
  v_exp_f32 v90, v74
  v_exp_f32 v91, v75
  v_add_f32 v26, v26, v88
  v_add_f32 v27, v27, v89
  v_cvt_pk_bf16_f32 v100, v88, v89
  s_nop 0
  v_exp_f32 v92, v76
  v_exp_f32 v93, v77
  v_add_f32 v26, v26, v90
  v_add_f32 v27, v27, v91
  v_cvt_pk_bf16_f32 v101, v90, v91
  s_nop 0
  v_exp_f32 v94, v78
  v_exp_f32 v95, v79
  v_add_f32 v26, v26, v92
  v_add_f32 v27, v27, v93
  v_cvt_pk_bf16_f32 v102, v92, v93
  s_nop 0
  v_add_f32 v26, v26, v94
  v_add_f32 v27, v27, v95
  v_cvt_pk_bf16_f32 v103, v94, v95
  s_nop 0
  v_add_f32 v26, v26, v27
  s_nop 1
  s_branch RET7
.section .rodata,"a"
.p2align 6
.amdhsa_kernel standalone__gqa_block_cached__near_ridge_kernel
  .amdhsa_next_free_vgpr 264
  .amdhsa_next_free_sgpr 102
  .amdhsa_accum_offset 232
  .amdhsa_group_segment_fixed_size 0
  .amdhsa_kernarg_size 64
  .amdhsa_user_sgpr_count 2
  .amdhsa_user_sgpr_kernarg_segment_ptr 1
  .amdhsa_system_sgpr_workgroup_id_x 1
  .amdhsa_float_denorm_mode_32 3
  .amdhsa_float_denorm_mode_16_64 3
.end_amdhsa_kernel
```
